```python
import torch

def _softmax(x, axis=-1):
    return torch.softmax(x, dim=axis)
def _gelu(x):
    return torch.nn.functional.gelu(x, approximate="tanh")
def _silu(x):
    return torch.nn.functional.silu(x)
def _sigmoid(x):
    return torch.sigmoid(x)
def _layernorm(x, axis=-1, eps=1e-5):
    m = x.mean(dim=axis, keepdim=True)
    v = x.var(dim=axis, keepdim=True, unbiased=False)
    return (x - m) / torch.sqrt(v + eps)
def _scatter_add(tgt, idx, src, axis=0):
    return tgt.clone().index_add_(axis, idx, src)
def _segment_sum(src, seg, n):
    out = torch.zeros((n,) + src.shape[1:], dtype=src.dtype)
    return out.index_add_(0, seg, src)
def _pad(x, pw):
    flat = tuple(v for pair in reversed(pw) for v in pair)
    return torch.nn.functional.pad(x, flat)

kernel_name = 'gated_mix__linear_attn_block__mixer_channel_mlp__prompt'

def setup_inputs():

    _w = (lambda a: (lambda t: t.to(torch.bfloat16) if t.is_floating_point() else t)(torch.as_tensor(a)))
    def _A_setup():
        B, S, D = 1, 2048, 576
        return {
            "x": _w((lambda *s: torch.randn(*s, dtype=torch.bfloat16) * 0.05)(B, S, D)),
            "wqkv": _w((lambda *s: torch.randn(*s, dtype=torch.bfloat16) * 0.8)(D, 3 * D)),
            "wo": _w((lambda *s: torch.randn(*s, dtype=torch.bfloat16) * 0.2)(D, D)),
        }
    _A_in = _A_setup()

    def _B_setup():
        B, S, D, F = 1, 2048, 576, 4608
        return {
            "x": _w((lambda *s: torch.randn(*s, dtype=torch.bfloat16) * 0.05)(B, S, D)),
            "w1": _w((lambda *s: torch.randn(*s, dtype=torch.bfloat16) * 1.6)(D, F) * (D ** -0.5)),
            "b1": _w((lambda *s: torch.randn(*s, dtype=torch.bfloat16) * 0.4)(F)),
            "w2": _w((lambda *s: torch.randn(*s, dtype=torch.bfloat16) * 0.05)(F, D) * (F ** -0.5)),
            "b2": _w((lambda *s: torch.randn(*s, dtype=torch.bfloat16) * 0.05)(D)),
        }
    _B_in = _B_setup()

    return {
        "A_x": _A_in["x"],
        "A_wqkv": _A_in["wqkv"],
        "A_wo": _A_in["wo"],
        "B_x": _B_in["x"],
        "B_w1": _B_in["w1"],
        "B_b1": _B_in["b1"],
        "B_w2": _B_in["w2"],
        "B_b2": _B_in["b2"],
        "gate_w": _w((lambda *s: torch.randn(*s, dtype=torch.bfloat16) * 0.05)(576) * 16.0),
    }

def reference(A_x, A_wqkv, A_wo, B_x, B_w1, B_b1, B_w2, B_b2, gate_w):
    def _A_ref(x, wqkv, wo):
        B, S, D = x.shape
        H = 32; Dh = D // H
        qkv = (lambda x, *d: x.permute(*d))((x @ wqkv).reshape(B, S, 3, H, Dh), 2, 0, 3, 1, 4)
        q, k, v = qkv[0], qkv[1], qkv[2]
        phi = lambda t: torch.where(t > 0, t + 1, torch.exp(t)) + 1e-6
        pq, pk = phi(q), phi(k)
        kv = torch.einsum("bhsd,bhse->bhde", pk, v)
        z = torch.einsum("bhsd->bhd", pk)
        num = torch.einsum("bhqd,bhde->bhqe", pq, kv)
        den = torch.einsum("bhqd,bhd->bhq", pq, z)[..., None] + 1e-6
        o = num / den
        return (lambda x, *d: x.permute(*d))(o, 0, 2, 1, 3).reshape(B, S, D) @ wo

    def _B_ref(x, w1, b1, w2, b2):
        y = _layernorm(x, axis=-1)
        h = _gelu(torch.einsum("bsd,df->bsf", y, w1) + b1)
        return torch.einsum("bsf,fd->bsd", h, w2) + b2

    x = A_x
    g = _sigmoid((x * gate_w).sum(-1, keepdims=True))
    a = _A_ref(x, A_wqkv, A_wo)
    b = _B_ref(x, B_w1, B_b1, B_w2, B_b2)
    return g * a + (1 - g) * b
```

```asm
; @launch grid=(256,1,1) block=(512,1,1) lds=163840
.amdgcn_target "amdgcn-amd-amdhsa--gfx950"

.text
.globl gated_mix__linear_attn_block__mixer_channel_mlp__prompt_kernel
.p2align 8
.type gated_mix__linear_attn_block__mixer_channel_mlp__prompt_kernel,@function
gated_mix__linear_attn_block__mixer_channel_mlp__prompt_kernel:
  s_cmp_ge_u32 s2, 256
  s_cbranch_scc1 L_end1
  s_load_dwordx2 s[12:13], s[0:1], 88
  s_load_dwordx2 s[16:17], s[0:1], 80
  s_and_b32 s42, s2, 7
  s_lshr_b32 s43, s2, 3
  s_cmp_ge_u32 s43, 24
  s_cbranch_scc1 L_attn
  s_load_dwordx2 s[4:5], s[0:1], 0
  s_load_dwordx2 s[8:9], s[0:1], 32
  s_load_dwordx2 s[20:21], s[0:1], 40
  s_load_dwordx2 s[24:25], s[0:1], 48
  s_lshr_b32 s29, s42, 1
  s_mul_i32 s29, s29, 3
  s_lshr_b32 s44, s43, 3
  s_add_u32 s29, s29, s44
  s_and_b32 s28, s42, 1
  s_lshl_b32 s28, s28, 3
  s_and_b32 s44, s43, 7
  s_add_u32 s28, s28, s44
  s_mul_i32 s44, s28, 43
  s_lshr_b32 s44, s44, 8
  s_mul_i32 s44, s44, 6
  s_sub_u32 s40, s28, s44
  s_cmp_ge_u32 s28, 9
  s_cselect_b32 s44, 9, 0
  s_sub_u32 s49, s28, s44
  s_mov_b32 s40, 0
  s_waitcnt lgkmcnt(0)
  s_mov_b32 s6, 2359296
  s_mov_b32 s7, 0x00020000
  s_mov_b32 s10, 5308416
  s_mov_b32 s11, 0x00020000
  s_mov_b32 s14, 268435456
  s_mov_b32 s15, 0x00020000
  s_mov_b32 s18, 256
  s_mov_b32 s19, 0x00020000
  s_mov_b32 s22, 9216
  s_mov_b32 s23, 0x00020000
  s_cmp_eq_u32 s2, 0
  s_cbranch_scc0 Lnn_1
  v_cmp_eq_u32 vcc, 0, v0
  s_and_saveexec_b64 s[94:95], vcc
  s_cbranch_execz Lnn_1_r
  s_memrealtime s[92:93]
  s_waitcnt lgkmcnt(0)
  s_or_b32 s92, s92, 1
  v_mov_b32 v2, s92
  v_mov_b32 v3, 252
  buffer_store_dword v2, v3, s[16:19], 0 offen sc0 sc1
Lnn_1_r:
  s_mov_b64 exec, s[94:95]
Lnn_1:
  v_and_b32 v1, 63, v0
  v_lshrrev_b32 v56, 6, v0
  s_nop 0
  v_readfirstlane_b32 s30, v56
  v_lshrrev_b32 v16, 3, v1
  v_and_b32 v18, 7, v1
  s_lshl_b32 s42, s30, 3
  v_add_u32 v16, s42, v16
  v_lshrrev_b32 v17, 1, v16
  v_and_b32 v17, 7, v17
  v_xor_b32 v17, v17, v18
  v_lshlrev_b32 v17, 4, v17
  v_mul_u32_u24 v19, 1152, v16
  v_add_u32 v19, v19, v17
  s_mul_i32 s47, s28, 147456
  s_lshl_b32 s48, s30, 10
  v_lshrrev_b32 v17, 4, v1
  v_and_b32 v17, 1, v17
  v_lshlrev_b32 v17, 2, v17
  v_xor_b32 v17, v17, v18
  v_lshlrev_b32 v17, 4, v17
  v_mul_u32_u24 v2, 9216, v16
  v_add_u32 v2, v2, v17
  v_mul_u32_u24 v3, 1152, v16
  v_add_u32 v3, v3, v17
  s_mul_i32 s33, s29, 384
  s_mov_b32 s36, s48
  s_mov_b32 s39, 589824
  s_lshl_b32 s42, s40, 6
  s_add_u32 s42, s42, s33
  s_lshl_b32 s38, s42, 1
  v_mul_u32_u24 v56, 1366, v0
  v_lshrrev_b32 v56, 16, v56
  v_mul_u32_u24 v57, 48, v56
  v_sub_u32 v57, v0, v57
  v_mul_u32_u24 v59, 1536, v56
  v_lshlrev_b32 v58, 5, v57
  v_add_u32 v59, v59, v58
  v_mul_u32_u24 v58, 36864, v56
  v_lshlrev_b32 v57, 4, v57
  v_add_u32 v58, v58, v57
  v_cmp_lt_u32 vcc, 8, v56
  v_mov_b32 v57, 1073741824
  s_mul_i32 s42, s28, 331776
  v_cndmask_b32 v58, v58, v57, vcc
  s_lshl_b32 s43, s33, 1
  s_add_u32 s42, s42, s43
  buffer_load_dwordx4 v[96:99], v58, s[8:11], s42 offen
  s_add_u32 s42, s42, 9216
  buffer_load_dwordx4 v[100:103], v58, s[8:11], s42 offen
  s_add_u32 s42, s42, 9216
  buffer_load_dwordx4 v[104:107], v58, s[8:11], s42 offen
  s_add_u32 s42, s42, 9216
  buffer_load_dwordx4 v[108:111], v58, s[8:11], s42 offen
  v_min_u32 v59, 15328, v59
  s_add_u32 m0, s48, 65536
  s_add_u32 s42, s47, 0
  buffer_load_dwordx4 v19, s[4:7], s42 offen lds
  s_add_u32 m0, s48, 73728
  s_add_u32 s42, s47, 73728
  buffer_load_dwordx4 v19, s[4:7], s42 offen lds
  s_and_b32 m0, s36, 65535
  s_add_u32 s36, s36, 8192
  buffer_load_dwordx4 v2, s[8:11], s38 offen lds
  s_add_u32 s38, s38, s39
  s_add_u32 m0, s48, 81920
  s_add_u32 s42, s47, 128
  buffer_load_dwordx4 v19, s[4:7], s42 offen lds
  s_add_u32 m0, s48, 90112
  s_add_u32 s42, s47, 73856
  buffer_load_dwordx4 v19, s[4:7], s42 offen lds
  s_and_b32 m0, s36, 65535
  s_add_u32 s36, s36, 8192
  buffer_load_dwordx4 v2, s[8:11], s38 offen lds
  s_add_u32 s38, s38, s39
  s_add_u32 m0, s48, 98304
  s_add_u32 s42, s47, 256
  buffer_load_dwordx4 v19, s[4:7], s42 offen lds
  s_add_u32 m0, s48, 106496
  s_add_u32 s42, s47, 73984
  buffer_load_dwordx4 v19, s[4:7], s42 offen lds
  s_and_b32 m0, s36, 65535
  s_add_u32 s36, s36, 8192
  buffer_load_dwordx4 v2, s[8:11], s38 offen lds
  s_add_u32 s38, s38, s39
  s_and_b32 s31, s30, 3
  s_lshr_b32 s32, s30, 2
  v_and_b32 v16, 15, v1
  v_lshrrev_b32 v16, 2, v16
  v_lshrrev_b32 v17, 1, v16
  v_xor_b32 v17, s32, v17
  v_lshlrev_b32 v17, 6, v17
  v_lshlrev_b32 v16, 7, v16
  v_add_u32 v16, v16, v17
  v_lshrrev_b32 v17, 4, v1
  v_and_b32 v17, 1, v17
  v_lshlrev_b32 v17, 5, v17
  v_add_u32 v16, v16, v17
  v_and_b32 v17, 3, v1
  v_lshlrev_b32 v17, 3, v17
  v_add_u32 v16, v16, v17
  v_lshrrev_b32 v17, 5, v1
  v_lshlrev_b32 v18, 10, v17
  v_add_u32 v4, v16, v18
  v_lshlrev_b32 v18, 9, v17
  v_add_u32 v7, v16, v18
  v_mov_b32 v5, v4
  v_mov_b32 v6, v4
  v_and_b32 v16, 31, v1
  v_lshlrev_b32 v9, 4, v16
  s_lshl_b32 s42, s31, 5
  v_add_u32 v16, s42, v16
  v_lshrrev_b32 v18, 1, v16
  v_and_b32 v18, 7, v18
  v_xor_b32 v18, v18, v17
  v_lshlrev_b32 v18, 4, v18
  v_lshlrev_b32 v16, 7, v16
  v_add_u32 v14, v16, v18
  v_add_u32 v14, 65536, v14
  v_lshlrev_b32 v15, 4, v1
  v_mov_b32 v13, 0
  s_waitcnt vmcnt(9)
  v_lshlrev_b32 v24, 16, v96
  v_and_b32 v25, 0xffff0000, v96
  v_lshlrev_b32 v26, 16, v97
  v_and_b32 v27, 0xffff0000, v97
  v_lshlrev_b32 v28, 16, v98
  v_and_b32 v29, 0xffff0000, v98
  v_lshlrev_b32 v30, 16, v99
  v_and_b32 v31, 0xffff0000, v99
  v_lshlrev_b32 v16, 16, v100
  v_and_b32 v17, 0xffff0000, v100
  v_add_f32 v24, v24, v16
  v_add_f32 v25, v25, v17
  v_lshlrev_b32 v16, 16, v101
  v_and_b32 v17, 0xffff0000, v101
  v_add_f32 v26, v26, v16
  v_add_f32 v27, v27, v17
  v_lshlrev_b32 v16, 16, v102
  v_and_b32 v17, 0xffff0000, v102
  v_add_f32 v28, v28, v16
  v_add_f32 v29, v29, v17
  v_lshlrev_b32 v16, 16, v103
  v_and_b32 v17, 0xffff0000, v103
  v_add_f32 v30, v30, v16
  v_add_f32 v31, v31, v17
  v_lshlrev_b32 v16, 16, v104
  v_and_b32 v17, 0xffff0000, v104
  v_add_f32 v24, v24, v16
  v_add_f32 v25, v25, v17
  v_lshlrev_b32 v16, 16, v105
  v_and_b32 v17, 0xffff0000, v105
  v_add_f32 v26, v26, v16
  v_add_f32 v27, v27, v17
  v_lshlrev_b32 v16, 16, v106
  v_and_b32 v17, 0xffff0000, v106
  v_add_f32 v28, v28, v16
  v_add_f32 v29, v29, v17
  v_lshlrev_b32 v16, 16, v107
  v_and_b32 v17, 0xffff0000, v107
  v_add_f32 v30, v30, v16
  v_add_f32 v31, v31, v17
  v_lshlrev_b32 v16, 16, v108
  v_and_b32 v17, 0xffff0000, v108
  v_add_f32 v24, v24, v16
  v_add_f32 v25, v25, v17
  v_lshlrev_b32 v16, 16, v109
  v_and_b32 v17, 0xffff0000, v109
  v_add_f32 v26, v26, v16
  v_add_f32 v27, v27, v17
  v_lshlrev_b32 v16, 16, v110
  v_and_b32 v17, 0xffff0000, v110
  v_add_f32 v28, v28, v16
  v_add_f32 v29, v29, v17
  v_lshlrev_b32 v16, 16, v111
  v_and_b32 v17, 0xffff0000, v111
  v_add_f32 v30, v30, v16
  v_add_f32 v31, v31, v17
  v_add_u32 v59, 49152, v59
  ds_write_b128 v59, v[24:27]
  ds_write_b128 v59, v[28:31] offset:16
  s_waitcnt vmcnt(6) lgkmcnt(0)
  s_barrier
  v_xor_b32 v60, 0, v14
  ds_read_b128 v[112:115], v60 offset:0
  v_xor_b32 v61, 32, v14
  ds_read_b128 v[116:119], v61 offset:0
  v_xor_b32 v60, 64, v14
  ds_read_b128 v[120:123], v60 offset:0
  v_xor_b32 v61, 96, v14
  ds_read_b128 v[124:127], v61 offset:0
  ds_read_b64_tr_b16 v[32:33], v6 offset:0
  ds_read_b64_tr_b16 v[34:35], v6 offset:512
  ds_read_b64_tr_b16 v[36:37], v6 offset:2048
  ds_read_b64_tr_b16 v[38:39], v6 offset:2560
  ds_read_b64_tr_b16 v[40:41], v6 offset:4096
  ds_read_b64_tr_b16 v[42:43], v6 offset:4608
  ds_read_b64_tr_b16 v[44:45], v6 offset:6144
  ds_read_b64_tr_b16 v[46:47], v6 offset:6656
  v_add_u16 v6, 8192, v6
  s_waitcnt vmcnt(3) lgkmcnt(4)
  s_barrier
  v_mfma_f32_32x32x16_bf16 v[64:79], v[32:35], v[112:115], 0
  v_lshlrev_b32 v20, 2, v0
  v_min_u32 v21, 1532, v20
  v_add_u32 v21, 49152, v21
  ds_read_b32 v96, v21 offset:0
  ds_read_b32 v97, v21 offset:1536
  ds_read_b32 v98, v21 offset:3072
  ds_read_b32 v99, v21 offset:4608
  ds_read_b32 v100, v21 offset:6144
  ds_read_b32 v101, v21 offset:7680
  ds_read_b32 v102, v21 offset:9216
  ds_read_b32 v103, v21 offset:10752
  ds_read_b32 v104, v21 offset:12288
  v_cmp_gt_u32 vcc, 384, v0
  v_mov_b32 v21, 1073741824
  s_mul_i32 s42, s29, 16
  v_cndmask_b32 v20, v21, v20, vcc
  s_add_u32 s42, s42, s28
  s_mul_i32 s42, s42, 1536
  s_add_u32 s43, s42, 37748736
  s_waitcnt lgkmcnt(0)
  v_add_f32 v96, v96, v97
  v_add_f32 v96, v96, v98
  v_add_f32 v96, v96, v99
  v_add_f32 v96, v96, v100
  v_add_f32 v96, v96, v101
  v_add_f32 v96, v96, v102
  v_add_f32 v96, v96, v103
  v_add_f32 v96, v96, v104
  buffer_store_dword v96, v20, s[12:15], s43 offen sc0 sc1
  ds_read_b64_tr_b16 v[48:49], v6 offset:0
  ds_read_b64_tr_b16 v[50:51], v6 offset:512
  s_and_b32 m0, s36, 65535
  s_add_u32 s36, s36, 8192
  buffer_load_dwordx4 v2, s[8:11], s38 offen lds
  s_add_u32 s38, s38, s39
  s_add_u32 m0, s48, 114688
  s_add_u32 s42, s47, 384
  buffer_load_dwordx4 v19, s[4:7], s42 offen lds
  s_add_u32 m0, s48, 122880
  s_add_u32 s42, s47, 74112
  buffer_load_dwordx4 v19, s[4:7], s42 offen lds
  v_xor_b32 v60, 0, v14
  ds_read_b128 v[128:131], v60 offset:16384
  v_xor_b32 v61, 32, v14
  ds_read_b128 v[132:135], v61 offset:16384
  v_xor_b32 v60, 64, v14
  ds_read_b128 v[136:139], v60 offset:16384
  v_xor_b32 v61, 96, v14
  ds_read_b128 v[140:143], v61 offset:16384
  v_mfma_f32_32x32x16_bf16 v[64:79], v[36:39], v[116:119], v[64:79]
  ds_read_b64_tr_b16 v[52:53], v6 offset:2048
  ds_read_b64_tr_b16 v[54:55], v6 offset:2560
  s_cmp_eq_u32 s32, 0
  s_cbranch_scc0 Lst_2
  v_dot2c_f32_bf16 v13, 0x3f803f80, v112
  v_dot2c_f32_bf16 v13, 0x3f803f80, v113
  v_dot2c_f32_bf16 v13, 0x3f803f80, v114
  v_dot2c_f32_bf16 v13, 0x3f803f80, v115
  v_dot2c_f32_bf16 v13, 0x3f803f80, v116
  v_dot2c_f32_bf16 v13, 0x3f803f80, v117
  v_dot2c_f32_bf16 v13, 0x3f803f80, v118
  v_dot2c_f32_bf16 v13, 0x3f803f80, v119
  v_dot2c_f32_bf16 v13, 0x3f803f80, v120
  v_dot2c_f32_bf16 v13, 0x3f803f80, v121
  v_dot2c_f32_bf16 v13, 0x3f803f80, v122
  v_dot2c_f32_bf16 v13, 0x3f803f80, v123
  v_dot2c_f32_bf16 v13, 0x3f803f80, v124
  v_dot2c_f32_bf16 v13, 0x3f803f80, v125
  v_dot2c_f32_bf16 v13, 0x3f803f80, v126
  v_dot2c_f32_bf16 v13, 0x3f803f80, v127
  s_branch Lst2_3
Lst_2:
  v_dot2c_f32_bf16 v13, v112, v112
  v_dot2c_f32_bf16 v13, v113, v113
  v_dot2c_f32_bf16 v13, v114, v114
  v_dot2c_f32_bf16 v13, v115, v115
  v_dot2c_f32_bf16 v13, v116, v116
  v_dot2c_f32_bf16 v13, v117, v117
  v_dot2c_f32_bf16 v13, v118, v118
  v_dot2c_f32_bf16 v13, v119, v119
  v_dot2c_f32_bf16 v13, v120, v120
  v_dot2c_f32_bf16 v13, v121, v121
  v_dot2c_f32_bf16 v13, v122, v122
  v_dot2c_f32_bf16 v13, v123, v123
  v_dot2c_f32_bf16 v13, v124, v124
  v_dot2c_f32_bf16 v13, v125, v125
  v_dot2c_f32_bf16 v13, v126, v126
  v_dot2c_f32_bf16 v13, v127, v127
Lst2_3:
  s_waitcnt lgkmcnt(15)
  v_mfma_f32_32x32x16_bf16 v[64:79], v[40:43], v[120:123], v[64:79]
  ds_read_b64_tr_b16 v[32:33], v6 offset:4096
  ds_read_b64_tr_b16 v[34:35], v6 offset:4608
  ds_read_b64_tr_b16 v[36:37], v6 offset:6144
  ds_read_b64_tr_b16 v[38:39], v6 offset:6656
  v_add_u16 v6, 8192, v6
  v_mfma_f32_32x32x16_bf16 v[64:79], v[44:47], v[124:127], v[64:79]
  s_waitcnt vmcnt(3) lgkmcnt(4)
  s_barrier
  v_mfma_f32_32x32x16_bf16 v[64:79], v[48:51], v[128:131], v[64:79]
  s_cmp_eq_u32 s30, 0
  s_cbranch_scc0 Lsig_4
  v_mov_b32 v56, 1
  s_lshl_b32 s42, s29, 2
  v_mov_b32 v57, s42
  s_mov_b64 exec, 1
  buffer_atomic_add v56, v57, s[16:19], 0 offen sc1
  s_mov_b64 exec, -1
Lsig_4:
  ds_read_b64_tr_b16 v[40:41], v6 offset:0
  ds_read_b64_tr_b16 v[42:43], v6 offset:512
  s_and_b32 m0, s36, 65535
  s_add_u32 s36, s36, 8192
  buffer_load_dwordx4 v2, s[8:11], s38 offen lds
  s_add_u32 s38, s38, s39
  s_add_u32 m0, s48, 131072
  s_add_u32 s42, s47, 512
  buffer_load_dwordx4 v19, s[4:7], s42 offen lds
  s_add_u32 m0, s48, 139264
  s_add_u32 s42, s47, 74240
  buffer_load_dwordx4 v19, s[4:7], s42 offen lds
  v_xor_b32 v60, 0, v14
  ds_read_b128 v[144:147], v60 offset:32768
  v_xor_b32 v61, 32, v14
  ds_read_b128 v[148:151], v61 offset:32768
  v_xor_b32 v60, 64, v14
  ds_read_b128 v[152:155], v60 offset:32768
  v_xor_b32 v61, 96, v14
  ds_read_b128 v[156:159], v61 offset:32768
  v_mfma_f32_32x32x16_bf16 v[64:79], v[52:55], v[132:135], v[64:79]
  ds_read_b64_tr_b16 v[44:45], v6 offset:2048
  ds_read_b64_tr_b16 v[46:47], v6 offset:2560
  s_cmp_eq_u32 s32, 0
  s_cbranch_scc0 Lst_5
  v_dot2c_f32_bf16 v13, 0x3f803f80, v128
  v_dot2c_f32_bf16 v13, 0x3f803f80, v129
  v_dot2c_f32_bf16 v13, 0x3f803f80, v130
  v_dot2c_f32_bf16 v13, 0x3f803f80, v131
  v_dot2c_f32_bf16 v13, 0x3f803f80, v132
  v_dot2c_f32_bf16 v13, 0x3f803f80, v133
  v_dot2c_f32_bf16 v13, 0x3f803f80, v134
  v_dot2c_f32_bf16 v13, 0x3f803f80, v135
  v_dot2c_f32_bf16 v13, 0x3f803f80, v136
  v_dot2c_f32_bf16 v13, 0x3f803f80, v137
  v_dot2c_f32_bf16 v13, 0x3f803f80, v138
  v_dot2c_f32_bf16 v13, 0x3f803f80, v139
  v_dot2c_f32_bf16 v13, 0x3f803f80, v140
  v_dot2c_f32_bf16 v13, 0x3f803f80, v141
  v_dot2c_f32_bf16 v13, 0x3f803f80, v142
  v_dot2c_f32_bf16 v13, 0x3f803f80, v143
  s_branch Lst2_6
Lst_5:
  v_dot2c_f32_bf16 v13, v128, v128
  v_dot2c_f32_bf16 v13, v129, v129
  v_dot2c_f32_bf16 v13, v130, v130
  v_dot2c_f32_bf16 v13, v131, v131
  v_dot2c_f32_bf16 v13, v132, v132
  v_dot2c_f32_bf16 v13, v133, v133
  v_dot2c_f32_bf16 v13, v134, v134
  v_dot2c_f32_bf16 v13, v135, v135
  v_dot2c_f32_bf16 v13, v136, v136
  v_dot2c_f32_bf16 v13, v137, v137
  v_dot2c_f32_bf16 v13, v138, v138
  v_dot2c_f32_bf16 v13, v139, v139
  v_dot2c_f32_bf16 v13, v140, v140
  v_dot2c_f32_bf16 v13, v141, v141
  v_dot2c_f32_bf16 v13, v142, v142
  v_dot2c_f32_bf16 v13, v143, v143
Lst2_6:
  s_waitcnt lgkmcnt(8)
  v_mfma_f32_32x32x16_bf16 v[64:79], v[32:35], v[136:139], v[64:79]
  ds_read_b64_tr_b16 v[48:49], v6 offset:4096
  ds_read_b64_tr_b16 v[50:51], v6 offset:4608
  ds_read_b64_tr_b16 v[52:53], v6 offset:6144
  ds_read_b64_tr_b16 v[54:55], v6 offset:6656
  v_add_u16 v6, 8192, v6
  v_mfma_f32_32x32x16_bf16 v[64:79], v[36:39], v[140:143], v[64:79]
  s_waitcnt vmcnt(3) lgkmcnt(4)
  s_barrier
  v_mfma_f32_32x32x16_bf16 v[64:79], v[40:43], v[144:147], v[64:79]
  ds_read_b64_tr_b16 v[32:33], v6 offset:0
  ds_read_b64_tr_b16 v[34:35], v6 offset:512
  s_and_b32 m0, s36, 65535
  s_add_u32 s36, s36, 8192
  buffer_load_dwordx4 v2, s[8:11], s38 offen lds
  s_add_u32 s38, s38, s39
  s_add_u32 m0, s48, 147456
  s_add_u32 s42, s47, 640
  buffer_load_dwordx4 v19, s[4:7], s42 offen lds
  s_add_u32 m0, s48, 155648
  s_add_u32 s42, s47, 74368
  buffer_load_dwordx4 v19, s[4:7], s42 offen lds
  v_xor_b32 v60, 0, v14
  ds_read_b128 v[160:163], v60 offset:49152
  v_xor_b32 v61, 32, v14
  ds_read_b128 v[164:167], v61 offset:49152
  v_xor_b32 v60, 64, v14
  ds_read_b128 v[168:171], v60 offset:49152
  v_xor_b32 v61, 96, v14
  ds_read_b128 v[172:175], v61 offset:49152
  v_mfma_f32_32x32x16_bf16 v[64:79], v[44:47], v[148:151], v[64:79]
  ds_read_b64_tr_b16 v[36:37], v6 offset:2048
  ds_read_b64_tr_b16 v[38:39], v6 offset:2560
  s_cmp_eq_u32 s32, 0
  s_cbranch_scc0 Lst_7
  v_dot2c_f32_bf16 v13, 0x3f803f80, v144
  v_dot2c_f32_bf16 v13, 0x3f803f80, v145
  v_dot2c_f32_bf16 v13, 0x3f803f80, v146
  v_dot2c_f32_bf16 v13, 0x3f803f80, v147
  v_dot2c_f32_bf16 v13, 0x3f803f80, v148
  v_dot2c_f32_bf16 v13, 0x3f803f80, v149
  v_dot2c_f32_bf16 v13, 0x3f803f80, v150
  v_dot2c_f32_bf16 v13, 0x3f803f80, v151
  v_dot2c_f32_bf16 v13, 0x3f803f80, v152
  v_dot2c_f32_bf16 v13, 0x3f803f80, v153
  v_dot2c_f32_bf16 v13, 0x3f803f80, v154
  v_dot2c_f32_bf16 v13, 0x3f803f80, v155
  v_dot2c_f32_bf16 v13, 0x3f803f80, v156
  v_dot2c_f32_bf16 v13, 0x3f803f80, v157
  v_dot2c_f32_bf16 v13, 0x3f803f80, v158
  v_dot2c_f32_bf16 v13, 0x3f803f80, v159
  s_branch Lst2_8
Lst_7:
  v_dot2c_f32_bf16 v13, v144, v144
  v_dot2c_f32_bf16 v13, v145, v145
  v_dot2c_f32_bf16 v13, v146, v146
  v_dot2c_f32_bf16 v13, v147, v147
  v_dot2c_f32_bf16 v13, v148, v148
  v_dot2c_f32_bf16 v13, v149, v149
  v_dot2c_f32_bf16 v13, v150, v150
  v_dot2c_f32_bf16 v13, v151, v151
  v_dot2c_f32_bf16 v13, v152, v152
  v_dot2c_f32_bf16 v13, v153, v153
  v_dot2c_f32_bf16 v13, v154, v154
  v_dot2c_f32_bf16 v13, v155, v155
  v_dot2c_f32_bf16 v13, v156, v156
  v_dot2c_f32_bf16 v13, v157, v157
  v_dot2c_f32_bf16 v13, v158, v158
  v_dot2c_f32_bf16 v13, v159, v159
Lst2_8:
  s_waitcnt lgkmcnt(8)
  v_mfma_f32_32x32x16_bf16 v[64:79], v[48:51], v[152:155], v[64:79]
  ds_read_b64_tr_b16 v[40:41], v6 offset:4096
  ds_read_b64_tr_b16 v[42:43], v6 offset:4608
  ds_read_b64_tr_b16 v[44:45], v6 offset:6144
  ds_read_b64_tr_b16 v[46:47], v6 offset:6656
  v_add_u16 v6, 8192, v6
  v_mfma_f32_32x32x16_bf16 v[64:79], v[52:55], v[156:159], v[64:79]
  s_waitcnt vmcnt(3) lgkmcnt(4)
  s_barrier
  v_mfma_f32_32x32x16_bf16 v[64:79], v[32:35], v[160:163], v[64:79]
  ds_read_b64_tr_b16 v[48:49], v6 offset:0
  ds_read_b64_tr_b16 v[50:51], v6 offset:512
  s_and_b32 m0, s36, 65535
  s_add_u32 s36, s36, 8192
  buffer_load_dwordx4 v2, s[8:11], s38 offen lds
  s_add_u32 s38, s38, s39
  s_add_u32 m0, s48, 65536
  s_add_u32 s42, s47, 768
  buffer_load_dwordx4 v19, s[4:7], s42 offen lds
  s_add_u32 m0, s48, 73728
  s_add_u32 s42, s47, 74496
  buffer_load_dwordx4 v19, s[4:7], s42 offen lds
  v_xor_b32 v60, 0, v14
  v_add_u32 v60, 65536, v60
  ds_read_b128 v[176:179], v60
  v_xor_b32 v61, 32, v14
  v_add_u32 v61, 65536, v61
  ds_read_b128 v[180:183], v61
  v_xor_b32 v60, 64, v14
  v_add_u32 v60, 65536, v60
  ds_read_b128 v[184:187], v60
  v_xor_b32 v61, 96, v14
  v_add_u32 v61, 65536, v61
  ds_read_b128 v[188:191], v61
  v_mfma_f32_32x32x16_bf16 v[64:79], v[36:39], v[164:167], v[64:79]
  ds_read_b64_tr_b16 v[52:53], v6 offset:2048
  ds_read_b64_tr_b16 v[54:55], v6 offset:2560
  s_cmp_eq_u32 s32, 0
  s_cbranch_scc0 Lst_9
  v_dot2c_f32_bf16 v13, 0x3f803f80, v160
  v_dot2c_f32_bf16 v13, 0x3f803f80, v161
  v_dot2c_f32_bf16 v13, 0x3f803f80, v162
  v_dot2c_f32_bf16 v13, 0x3f803f80, v163
  v_dot2c_f32_bf16 v13, 0x3f803f80, v164
  v_dot2c_f32_bf16 v13, 0x3f803f80, v165
  v_dot2c_f32_bf16 v13, 0x3f803f80, v166
  v_dot2c_f32_bf16 v13, 0x3f803f80, v167
  v_dot2c_f32_bf16 v13, 0x3f803f80, v168
  v_dot2c_f32_bf16 v13, 0x3f803f80, v169
  v_dot2c_f32_bf16 v13, 0x3f803f80, v170
  v_dot2c_f32_bf16 v13, 0x3f803f80, v171
  v_dot2c_f32_bf16 v13, 0x3f803f80, v172
  v_dot2c_f32_bf16 v13, 0x3f803f80, v173
  v_dot2c_f32_bf16 v13, 0x3f803f80, v174
  v_dot2c_f32_bf16 v13, 0x3f803f80, v175
  s_branch Lst2_10
Lst_9:
  v_dot2c_f32_bf16 v13, v160, v160
  v_dot2c_f32_bf16 v13, v161, v161
  v_dot2c_f32_bf16 v13, v162, v162
  v_dot2c_f32_bf16 v13, v163, v163
  v_dot2c_f32_bf16 v13, v164, v164
  v_dot2c_f32_bf16 v13, v165, v165
  v_dot2c_f32_bf16 v13, v166, v166
  v_dot2c_f32_bf16 v13, v167, v167
  v_dot2c_f32_bf16 v13, v168, v168
  v_dot2c_f32_bf16 v13, v169, v169
  v_dot2c_f32_bf16 v13, v170, v170
  v_dot2c_f32_bf16 v13, v171, v171
  v_dot2c_f32_bf16 v13, v172, v172
  v_dot2c_f32_bf16 v13, v173, v173
  v_dot2c_f32_bf16 v13, v174, v174
  v_dot2c_f32_bf16 v13, v175, v175
Lst2_10:
  s_waitcnt lgkmcnt(8)
  v_mfma_f32_32x32x16_bf16 v[64:79], v[40:43], v[168:171], v[64:79]
  ds_read_b64_tr_b16 v[32:33], v6 offset:4096
  ds_read_b64_tr_b16 v[34:35], v6 offset:4608
  ds_read_b64_tr_b16 v[36:37], v6 offset:6144
  ds_read_b64_tr_b16 v[38:39], v6 offset:6656
  v_add_u16 v6, 8192, v6
  v_mfma_f32_32x32x16_bf16 v[64:79], v[44:47], v[172:175], v[64:79]
  s_waitcnt vmcnt(3) lgkmcnt(4)
  s_barrier
  v_mfma_f32_32x32x16_bf16 v[64:79], v[48:51], v[176:179], v[64:79]
  ds_read_b64_tr_b16 v[40:41], v6 offset:0
  ds_read_b64_tr_b16 v[42:43], v6 offset:512
  s_and_b32 m0, s36, 65535
  s_add_u32 s36, s36, 8192
  buffer_load_dwordx4 v2, s[8:11], s38 offen lds
  s_add_u32 s38, s38, s39
  s_add_u32 m0, s48, 81920
  s_add_u32 s42, s47, 896
  buffer_load_dwordx4 v19, s[4:7], s42 offen lds
  s_add_u32 m0, s48, 90112
  s_add_u32 s42, s47, 74624
  buffer_load_dwordx4 v19, s[4:7], s42 offen lds
  v_xor_b32 v60, 0, v14
  v_add_u32 v60, 81920, v60
  ds_read_b128 v[192:195], v60
  v_xor_b32 v61, 32, v14
  v_add_u32 v61, 81920, v61
  ds_read_b128 v[196:199], v61
  v_xor_b32 v60, 64, v14
  v_add_u32 v60, 81920, v60
  ds_read_b128 v[200:203], v60
  v_xor_b32 v61, 96, v14
  v_add_u32 v61, 81920, v61
  ds_read_b128 v[204:207], v61
  v_mfma_f32_32x32x16_bf16 v[64:79], v[52:55], v[180:183], v[64:79]
  ds_read_b64_tr_b16 v[44:45], v6 offset:2048
  ds_read_b64_tr_b16 v[46:47], v6 offset:2560
  s_cmp_eq_u32 s32, 0
  s_cbranch_scc0 Lst_11
  v_dot2c_f32_bf16 v13, 0x3f803f80, v176
  v_dot2c_f32_bf16 v13, 0x3f803f80, v177
  v_dot2c_f32_bf16 v13, 0x3f803f80, v178
  v_dot2c_f32_bf16 v13, 0x3f803f80, v179
  v_dot2c_f32_bf16 v13, 0x3f803f80, v180
  v_dot2c_f32_bf16 v13, 0x3f803f80, v181
  v_dot2c_f32_bf16 v13, 0x3f803f80, v182
  v_dot2c_f32_bf16 v13, 0x3f803f80, v183
  v_dot2c_f32_bf16 v13, 0x3f803f80, v184
  v_dot2c_f32_bf16 v13, 0x3f803f80, v185
  v_dot2c_f32_bf16 v13, 0x3f803f80, v186
  v_dot2c_f32_bf16 v13, 0x3f803f80, v187
  v_dot2c_f32_bf16 v13, 0x3f803f80, v188
  v_dot2c_f32_bf16 v13, 0x3f803f80, v189
  v_dot2c_f32_bf16 v13, 0x3f803f80, v190
  v_dot2c_f32_bf16 v13, 0x3f803f80, v191
  s_branch Lst2_12
Lst_11:
  v_dot2c_f32_bf16 v13, v176, v176
  v_dot2c_f32_bf16 v13, v177, v177
  v_dot2c_f32_bf16 v13, v178, v178
  v_dot2c_f32_bf16 v13, v179, v179
  v_dot2c_f32_bf16 v13, v180, v180
  v_dot2c_f32_bf16 v13, v181, v181
  v_dot2c_f32_bf16 v13, v182, v182
  v_dot2c_f32_bf16 v13, v183, v183
  v_dot2c_f32_bf16 v13, v184, v184
  v_dot2c_f32_bf16 v13, v185, v185
  v_dot2c_f32_bf16 v13, v186, v186
  v_dot2c_f32_bf16 v13, v187, v187
  v_dot2c_f32_bf16 v13, v188, v188
  v_dot2c_f32_bf16 v13, v189, v189
  v_dot2c_f32_bf16 v13, v190, v190
  v_dot2c_f32_bf16 v13, v191, v191
Lst2_12:
  s_waitcnt lgkmcnt(8)
  v_mfma_f32_32x32x16_bf16 v[64:79], v[32:35], v[184:187], v[64:79]
  ds_read_b64_tr_b16 v[48:49], v6 offset:4096
  ds_read_b64_tr_b16 v[50:51], v6 offset:4608
  ds_read_b64_tr_b16 v[52:53], v6 offset:6144
  ds_read_b64_tr_b16 v[54:55], v6 offset:6656
  v_add_u16 v6, 8192, v6
  v_mfma_f32_32x32x16_bf16 v[64:79], v[36:39], v[188:191], v[64:79]
  s_waitcnt vmcnt(3) lgkmcnt(4)
  s_barrier
  v_mfma_f32_32x32x16_bf16 v[64:79], v[40:43], v[192:195], v[64:79]
  ds_read_b64_tr_b16 v[32:33], v6 offset:0
  ds_read_b64_tr_b16 v[34:35], v6 offset:512
  s_and_b32 m0, s36, 65535
  s_add_u32 s36, s36, 8192
  buffer_load_dwordx4 v2, s[8:11], s38 offen lds
  s_add_u32 s38, s38, s39
  s_add_u32 m0, s48, 98304
  s_add_u32 s42, s47, 1024
  buffer_load_dwordx4 v19, s[4:7], s42 offen lds
  s_add_u32 m0, s48, 106496
  s_add_u32 s42, s47, 74752
  buffer_load_dwordx4 v19, s[4:7], s42 offen lds
  v_xor_b32 v60, 0, v14
  ds_read_b128 v[208:211], v60 offset:0
  v_xor_b32 v61, 32, v14
  ds_read_b128 v[212:215], v61 offset:0
  v_xor_b32 v60, 64, v14
  ds_read_b128 v[216:219], v60 offset:0
  v_xor_b32 v61, 96, v14
  ds_read_b128 v[220:223], v61 offset:0
  v_mfma_f32_32x32x16_bf16 v[64:79], v[44:47], v[196:199], v[64:79]
  ds_read_b64_tr_b16 v[36:37], v6 offset:2048
  ds_read_b64_tr_b16 v[38:39], v6 offset:2560
  s_cmp_eq_u32 s32, 0
  s_cbranch_scc0 Lst_13
  v_dot2c_f32_bf16 v13, 0x3f803f80, v192
  v_dot2c_f32_bf16 v13, 0x3f803f80, v193
  v_dot2c_f32_bf16 v13, 0x3f803f80, v194
  v_dot2c_f32_bf16 v13, 0x3f803f80, v195
  v_dot2c_f32_bf16 v13, 0x3f803f80, v196
  v_dot2c_f32_bf16 v13, 0x3f803f80, v197
  v_dot2c_f32_bf16 v13, 0x3f803f80, v198
  v_dot2c_f32_bf16 v13, 0x3f803f80, v199
  v_dot2c_f32_bf16 v13, 0x3f803f80, v200
  v_dot2c_f32_bf16 v13, 0x3f803f80, v201
  v_dot2c_f32_bf16 v13, 0x3f803f80, v202
  v_dot2c_f32_bf16 v13, 0x3f803f80, v203
  v_dot2c_f32_bf16 v13, 0x3f803f80, v204
  v_dot2c_f32_bf16 v13, 0x3f803f80, v205
  v_dot2c_f32_bf16 v13, 0x3f803f80, v206
  v_dot2c_f32_bf16 v13, 0x3f803f80, v207
  s_branch Lst2_14
Lst_13:
  v_dot2c_f32_bf16 v13, v192, v192
  v_dot2c_f32_bf16 v13, v193, v193
  v_dot2c_f32_bf16 v13, v194, v194
  v_dot2c_f32_bf16 v13, v195, v195
  v_dot2c_f32_bf16 v13, v196, v196
  v_dot2c_f32_bf16 v13, v197, v197
  v_dot2c_f32_bf16 v13, v198, v198
  v_dot2c_f32_bf16 v13, v199, v199
  v_dot2c_f32_bf16 v13, v200, v200
  v_dot2c_f32_bf16 v13, v201, v201
  v_dot2c_f32_bf16 v13, v202, v202
  v_dot2c_f32_bf16 v13, v203, v203
  v_dot2c_f32_bf16 v13, v204, v204
  v_dot2c_f32_bf16 v13, v205, v205
  v_dot2c_f32_bf16 v13, v206, v206
  v_dot2c_f32_bf16 v13, v207, v207
Lst2_14:
  s_waitcnt lgkmcnt(8)
  v_mfma_f32_32x32x16_bf16 v[64:79], v[48:51], v[200:203], v[64:79]
  ds_read_b64_tr_b16 v[40:41], v6 offset:4096
  ds_read_b64_tr_b16 v[42:43], v6 offset:4608
  s_add_u32 s41, s40, 1
  s_cmp_eq_u32 s41, 6
  s_cselect_b32 s41, 0, s41
  s_lshl_b32 s42, s41, 6
  s_add_u32 s42, s42, s33
  s_lshl_b32 s38, s42, 1
  ds_read_b64_tr_b16 v[44:45], v6 offset:6144
  ds_read_b64_tr_b16 v[46:47], v6 offset:6656
  v_add_u16 v6, 8192, v6
  v_mfma_f32_32x32x16_bf16 v[64:79], v[52:55], v[204:207], v[64:79]
  s_waitcnt vmcnt(3) lgkmcnt(4)
  s_barrier
  v_mfma_f32_32x32x16_bf16 v[64:79], v[32:35], v[208:211], v[64:79]
  s_lshl_b32 s42, s29, 2
  v_mov_b32 v20, s42
  buffer_load_dword v21, v20, s[16:19], 0 offen sc1
  ds_read_b64_tr_b16 v[48:49], v6 offset:0
  ds_read_b64_tr_b16 v[50:51], v6 offset:512
  s_and_b32 m0, s36, 65535
  s_add_u32 s36, s36, 8192
  buffer_load_dwordx4 v2, s[8:11], s38 offen lds
  s_add_u32 s38, s38, s39
  s_and_b32 m0, s36, 65535
  s_add_u32 s36, s36, 8192
  buffer_load_dwordx4 v2, s[8:11], s38 offen lds
  s_add_u32 s38, s38, s39
  v_xor_b32 v60, 0, v14
  ds_read_b128 v[224:227], v60 offset:16384
  v_xor_b32 v61, 32, v14
  ds_read_b128 v[228:231], v61 offset:16384
  v_xor_b32 v60, 64, v14
  ds_read_b128 v[232:235], v60 offset:16384
  v_xor_b32 v61, 96, v14
  ds_read_b128 v[236:239], v61 offset:16384
  v_mfma_f32_32x32x16_bf16 v[64:79], v[36:39], v[212:215], v[64:79]
  ds_read_b64_tr_b16 v[52:53], v6 offset:2048
  ds_read_b64_tr_b16 v[54:55], v6 offset:2560
  s_cmp_eq_u32 s32, 0
  s_cbranch_scc0 Lst_15
  v_dot2c_f32_bf16 v13, 0x3f803f80, v208
  v_dot2c_f32_bf16 v13, 0x3f803f80, v209
  v_dot2c_f32_bf16 v13, 0x3f803f80, v210
  v_dot2c_f32_bf16 v13, 0x3f803f80, v211
  v_dot2c_f32_bf16 v13, 0x3f803f80, v212
  v_dot2c_f32_bf16 v13, 0x3f803f80, v213
  v_dot2c_f32_bf16 v13, 0x3f803f80, v214
  v_dot2c_f32_bf16 v13, 0x3f803f80, v215
  v_dot2c_f32_bf16 v13, 0x3f803f80, v216
  v_dot2c_f32_bf16 v13, 0x3f803f80, v217
  v_dot2c_f32_bf16 v13, 0x3f803f80, v218
  v_dot2c_f32_bf16 v13, 0x3f803f80, v219
  v_dot2c_f32_bf16 v13, 0x3f803f80, v220
  v_dot2c_f32_bf16 v13, 0x3f803f80, v221
  v_dot2c_f32_bf16 v13, 0x3f803f80, v222
  v_dot2c_f32_bf16 v13, 0x3f803f80, v223
  s_branch Lst2_16
Lst_15:
  v_dot2c_f32_bf16 v13, v208, v208
  v_dot2c_f32_bf16 v13, v209, v209
  v_dot2c_f32_bf16 v13, v210, v210
  v_dot2c_f32_bf16 v13, v211, v211
  v_dot2c_f32_bf16 v13, v212, v212
  v_dot2c_f32_bf16 v13, v213, v213
  v_dot2c_f32_bf16 v13, v214, v214
  v_dot2c_f32_bf16 v13, v215, v215
  v_dot2c_f32_bf16 v13, v216, v216
  v_dot2c_f32_bf16 v13, v217, v217
  v_dot2c_f32_bf16 v13, v218, v218
  v_dot2c_f32_bf16 v13, v219, v219
  v_dot2c_f32_bf16 v13, v220, v220
  v_dot2c_f32_bf16 v13, v221, v221
  v_dot2c_f32_bf16 v13, v222, v222
  v_dot2c_f32_bf16 v13, v223, v223
Lst2_16:
  s_waitcnt lgkmcnt(8)
  v_mfma_f32_32x32x16_bf16 v[64:79], v[40:43], v[216:219], v[64:79]
  ds_read_b64_tr_b16 v[32:33], v6 offset:4096
  ds_read_b64_tr_b16 v[34:35], v6 offset:4608
  ds_read_b64_tr_b16 v[36:37], v6 offset:6144
  ds_read_b64_tr_b16 v[38:39], v6 offset:6656
  v_add_u16 v6, 8192, v6
  v_mfma_f32_32x32x16_bf16 v[64:79], v[44:47], v[220:223], v[64:79]
  s_waitcnt vmcnt(3) lgkmcnt(4)
  s_barrier
  v_mfma_f32_32x32x16_bf16 v[64:79], v[48:51], v[224:227], v[64:79]
  ds_read_b64_tr_b16 v[40:41], v6 offset:0
  ds_read_b64_tr_b16 v[42:43], v6 offset:512
  s_and_b32 m0, s36, 65535
  s_add_u32 s36, s36, 8192
  buffer_load_dwordx4 v2, s[8:11], s38 offen lds
  s_add_u32 s38, s38, s39
  s_and_b32 m0, s36, 65535
  s_add_u32 s36, s36, 8192
  buffer_load_dwordx4 v2, s[8:11], s38 offen lds
  s_add_u32 s38, s38, s39
  v_xor_b32 v60, 0, v14
  ds_read_b128 v[240:243], v60 offset:32768
  v_xor_b32 v61, 32, v14
  ds_read_b128 v[244:247], v61 offset:32768
  v_xor_b32 v60, 64, v14
  ds_read_b128 v[248:251], v60 offset:32768
  v_xor_b32 v61, 96, v14
  ds_read_b128 v[252:255], v61 offset:32768
  v_mfma_f32_32x32x16_bf16 v[64:79], v[52:55], v[228:231], v[64:79]
  ds_read_b64_tr_b16 v[44:45], v6 offset:2048
  ds_read_b64_tr_b16 v[46:47], v6 offset:2560
  s_cmp_eq_u32 s32, 0
  s_cbranch_scc0 Lst_17
  v_dot2c_f32_bf16 v13, 0x3f803f80, v224
  v_dot2c_f32_bf16 v13, 0x3f803f80, v225
  v_dot2c_f32_bf16 v13, 0x3f803f80, v226
  v_dot2c_f32_bf16 v13, 0x3f803f80, v227
  v_dot2c_f32_bf16 v13, 0x3f803f80, v228
  v_dot2c_f32_bf16 v13, 0x3f803f80, v229
  v_dot2c_f32_bf16 v13, 0x3f803f80, v230
  v_dot2c_f32_bf16 v13, 0x3f803f80, v231
  v_dot2c_f32_bf16 v13, 0x3f803f80, v232
  v_dot2c_f32_bf16 v13, 0x3f803f80, v233
  v_dot2c_f32_bf16 v13, 0x3f803f80, v234
  v_dot2c_f32_bf16 v13, 0x3f803f80, v235
  v_dot2c_f32_bf16 v13, 0x3f803f80, v236
  v_dot2c_f32_bf16 v13, 0x3f803f80, v237
  v_dot2c_f32_bf16 v13, 0x3f803f80, v238
  v_dot2c_f32_bf16 v13, 0x3f803f80, v239
  s_branch Lst2_18
Lst_17:
  v_dot2c_f32_bf16 v13, v224, v224
  v_dot2c_f32_bf16 v13, v225, v225
  v_dot2c_f32_bf16 v13, v226, v226
  v_dot2c_f32_bf16 v13, v227, v227
  v_dot2c_f32_bf16 v13, v228, v228
  v_dot2c_f32_bf16 v13, v229, v229
  v_dot2c_f32_bf16 v13, v230, v230
  v_dot2c_f32_bf16 v13, v231, v231
  v_dot2c_f32_bf16 v13, v232, v232
  v_dot2c_f32_bf16 v13, v233, v233
  v_dot2c_f32_bf16 v13, v234, v234
  v_dot2c_f32_bf16 v13, v235, v235
  v_dot2c_f32_bf16 v13, v236, v236
  v_dot2c_f32_bf16 v13, v237, v237
  v_dot2c_f32_bf16 v13, v238, v238
  v_dot2c_f32_bf16 v13, v239, v239
Lst2_18:
  s_waitcnt lgkmcnt(8)
  v_mfma_f32_32x32x16_bf16 v[64:79], v[32:35], v[232:235], v[64:79]
  ds_read_b64_tr_b16 v[48:49], v6 offset:4096
  ds_read_b64_tr_b16 v[50:51], v6 offset:4608
  ds_read_b64_tr_b16 v[52:53], v6 offset:6144
  ds_read_b64_tr_b16 v[54:55], v6 offset:6656
  v_add_u16 v6, 8192, v6
  v_mfma_f32_32x32x16_bf16 v[64:79], v[36:39], v[236:239], v[64:79]
  s_waitcnt vmcnt(3) lgkmcnt(4)
  s_barrier
  v_mfma_f32_32x32x16_bf16 v[64:79], v[40:43], v[240:243], v[64:79]
  v_readfirstlane_b32 s42, v21
  s_mov_b32 s55, 0
  s_nop 2
  s_cmp_ge_u32 s42, 16
  s_cbranch_scc0 L_notyet
  s_mov_b32 s55, 1
  v_lshlrev_b32 v59, 4, v0
  s_mul_i32 s42, s29, 24576
  s_add_u32 s42, s42, 37748736
  buffer_load_dwordx4 v[96:99], v59, s[12:15], s42 offen sc0 sc1
  s_add_u32 s42, s42, 8192
  buffer_load_dwordx4 v[100:103], v59, s[12:15], s42 offen sc0 sc1
  s_add_u32 s42, s42, 8192
  buffer_load_dwordx4 v[104:107], v59, s[12:15], s42 offen sc0 sc1
  v_lshlrev_b32 v58, 1, v0
  v_cmp_gt_u32 vcc, 384, v0
  v_mov_b32 v108, 1073741824
  s_lshl_b32 s42, s33, 1
  v_cndmask_b32 v58, v108, v58, vcc
  buffer_load_ushort v31, v58, s[20:23], s42 offen
L_notyet:
  ds_read_b64_tr_b16 v[32:33], v6 offset:0
  ds_read_b64_tr_b16 v[34:35], v6 offset:512
  s_and_b32 m0, s36, 65535
  s_add_u32 s36, s36, 8192
  buffer_load_dwordx4 v2, s[8:11], s38 offen lds
  s_add_u32 s38, s38, s39
  s_and_b32 m0, s36, 65535
  s_add_u32 s36, s36, 8192
  buffer_load_dwordx4 v2, s[8:11], s38 offen lds
  s_add_u32 s38, s38, s39
  v_mfma_f32_32x32x16_bf16 v[64:79], v[44:47], v[244:247], v[64:79]
  ds_read_b64_tr_b16 v[36:37], v6 offset:2048
  ds_read_b64_tr_b16 v[38:39], v6 offset:2560
  s_cmp_eq_u32 s32, 0
  s_cbranch_scc0 Lst_19
  v_dot2c_f32_bf16 v13, 0x3f803f80, v240
  v_dot2c_f32_bf16 v13, 0x3f803f80, v241
  v_dot2c_f32_bf16 v13, 0x3f803f80, v242
  v_dot2c_f32_bf16 v13, 0x3f803f80, v243
  v_dot2c_f32_bf16 v13, 0x3f803f80, v244
  v_dot2c_f32_bf16 v13, 0x3f803f80, v245
  v_dot2c_f32_bf16 v13, 0x3f803f80, v246
  v_dot2c_f32_bf16 v13, 0x3f803f80, v247
  v_dot2c_f32_bf16 v13, 0x3f803f80, v248
  v_dot2c_f32_bf16 v13, 0x3f803f80, v249
  v_dot2c_f32_bf16 v13, 0x3f803f80, v250
  v_dot2c_f32_bf16 v13, 0x3f803f80, v251
  v_dot2c_f32_bf16 v13, 0x3f803f80, v252
  v_dot2c_f32_bf16 v13, 0x3f803f80, v253
  v_dot2c_f32_bf16 v13, 0x3f803f80, v254
  v_dot2c_f32_bf16 v13, 0x3f803f80, v255
  s_branch Lst2_20
Lst_19:
  v_dot2c_f32_bf16 v13, v240, v240
  v_dot2c_f32_bf16 v13, v241, v241
  v_dot2c_f32_bf16 v13, v242, v242
  v_dot2c_f32_bf16 v13, v243, v243
  v_dot2c_f32_bf16 v13, v244, v244
  v_dot2c_f32_bf16 v13, v245, v245
  v_dot2c_f32_bf16 v13, v246, v246
  v_dot2c_f32_bf16 v13, v247, v247
  v_dot2c_f32_bf16 v13, v248, v248
  v_dot2c_f32_bf16 v13, v249, v249
  v_dot2c_f32_bf16 v13, v250, v250
  v_dot2c_f32_bf16 v13, v251, v251
  v_dot2c_f32_bf16 v13, v252, v252
  v_dot2c_f32_bf16 v13, v253, v253
  v_dot2c_f32_bf16 v13, v254, v254
  v_dot2c_f32_bf16 v13, v255, v255
Lst2_20:
  s_waitcnt lgkmcnt(4)
  v_mfma_f32_32x32x16_bf16 v[64:79], v[48:51], v[248:251], v[64:79]
  ds_read_b64_tr_b16 v[40:41], v6 offset:4096
  ds_read_b64_tr_b16 v[42:43], v6 offset:4608
  ds_read_b64_tr_b16 v[44:45], v6 offset:6144
  ds_read_b64_tr_b16 v[46:47], v6 offset:6656
  v_add_u16 v6, 8192, v6
  v_mfma_f32_32x32x16_bf16 v[80:95], v[52:55], v[252:255], v[64:79]
  s_nop 3
  v_mov_b32 v56, v13
  s_nop 1
  v_permlane32_swap_b32 v13, v56
  s_nop 1
  v_add_f32 v13, v13, v56
  s_lshl_b32 s42, s31, 8
  s_lshl_b32 s43, s32, 7
  s_add_u32 s42, s42, s43
  s_add_u32 s42, s42, 66560
  v_lshrrev_b32 v57, 2, v9
  v_add_u32 v56, s42, v57
  ds_write_b32 v56, v13
  s_cmp_eq_u32 s55, 1
  s_cbranch_scc1 L_haveflag
  s_lshl_b32 s42, s29, 2
  v_mov_b32 v20, s42
L_poll:
  buffer_load_dword v21, v20, s[16:19], 0 offen sc1
  s_waitcnt vmcnt(0)
  v_readfirstlane_b32 s42, v21
  s_nop 3
  s_cmp_ge_u32 s42, 16
  s_cbranch_scc1 L_polled
  s_sleep 1
  s_branch L_poll
L_polled:
  v_lshlrev_b32 v59, 4, v0
  s_mul_i32 s42, s29, 24576
  s_add_u32 s42, s42, 37748736
  buffer_load_dwordx4 v[96:99], v59, s[12:15], s42 offen sc0 sc1
  s_add_u32 s42, s42, 8192
  buffer_load_dwordx4 v[100:103], v59, s[12:15], s42 offen sc0 sc1
  s_add_u32 s42, s42, 8192
  buffer_load_dwordx4 v[104:107], v59, s[12:15], s42 offen sc0 sc1
  v_lshlrev_b32 v58, 1, v0
  v_cmp_gt_u32 vcc, 384, v0
  v_mov_b32 v108, 1073741824
  s_lshl_b32 s42, s33, 1
  v_cndmask_b32 v58, v108, v58, vcc
  buffer_load_ushort v31, v58, s[20:23], s42 offen
  s_waitcnt vmcnt(0)
L_haveflag:
  s_waitcnt vmcnt(2)
  v_lshlrev_b32 v59, 4, v0
  v_add_u32 v59, 98304, v59
  ds_write_b128 v59, v[96:99] offset:0
  ds_write_b128 v59, v[100:103] offset:8192
  ds_write_b128 v59, v[104:107] offset:16384
  s_waitcnt lgkmcnt(0)
  s_barrier
  v_lshlrev_b32 v59, 2, v0
  v_min_u32 v59, 1532, v59
  v_add_u32 v59, 98304, v59
  ds_read_b32 v96, v59 offset:0
  ds_read_b32 v97, v59 offset:1536
  ds_read_b32 v98, v59 offset:3072
  ds_read_b32 v99, v59 offset:4608
  ds_read_b32 v100, v59 offset:6144
  ds_read_b32 v101, v59 offset:7680
  ds_read_b32 v102, v59 offset:9216
  ds_read_b32 v103, v59 offset:10752
  ds_read_b32 v104, v59 offset:12288
  ds_read_b32 v105, v59 offset:13824
  ds_read_b32 v106, v59 offset:15360
  ds_read_b32 v107, v59 offset:16896
  ds_read_b32 v108, v59 offset:18432
  ds_read_b32 v109, v59 offset:19968
  ds_read_b32 v110, v59 offset:21504
  ds_read_b32 v111, v59 offset:23040
  s_lshl_b32 s42, s31, 8
  s_add_u32 s42, s42, 66560
  v_add_u32 v56, s42, v57
  ds_read_b32 v16, v56
  ds_read_b32 v17, v56 offset:128
  s_waitcnt lgkmcnt(0)
  v_mul_f32 v16, 0x3ae38e39, v16
  v_mul_f32 v17, 0x3ae38e39, v17
  v_fma_f32 v17, -v16, v16, v17
  v_max_f32 v17, 0, v17
  v_add_f32 v17, 0x3727c5ac, v17
  v_sqrt_f32 v18, v17
  s_nop 0
  v_rcp_f32 v12, v18
  s_nop 0
  v_mul_f32 v10, 0xc0135761, v12
  v_mul_f32 v11, v12, v12
  v_mul_f32 v11, v11, v12
  v_mul_f32 v11, 0xbdd2d3e8, v11
  v_add_f32 v96, v96, v97
  v_add_f32 v96, v96, v98
  v_add_f32 v96, v96, v99
  v_add_f32 v96, v96, v100
  v_add_f32 v96, v96, v101
  v_add_f32 v96, v96, v102
  v_add_f32 v96, v96, v103
  v_add_f32 v96, v96, v104
  v_add_f32 v96, v96, v105
  v_add_f32 v96, v96, v106
  v_add_f32 v96, v96, v107
  v_add_f32 v96, v96, v108
  v_add_f32 v96, v96, v109
  v_add_f32 v96, v96, v110
  v_add_f32 v96, v96, v111
  s_barrier
  v_cvt_pk_bf16_f32 v24, v96, v96
  v_lshlrev_b32 v97, 16, v24
  v_sub_f32 v97, v96, v97
  v_cvt_pk_bf16_f32 v97, v97, v97
  v_and_b32 v97, 0xffff, v97
  v_lshlrev_b32 v98, 16, v31
  v_or_b32 v25, v97, v98
  v_mov_b32 v26, v31
  v_mov_b32 v27, 0
  v_lshrrev_b32 v59, 5, v0
  v_lshlrev_b32 v59, 11, v59
  v_add_u32 v59, v59, v9
  v_add_u32 v59, 65536, v59
  v_cmp_gt_u32 vcc, 384, v0
  s_and_saveexec_b64 s[52:53], vcc
  s_cbranch_execz L_notab
  ds_write_b128 v59, v[24:27] offset:0
  ds_write_b128 v59, v[24:27] offset:24576
  ds_write_b128 v59, v[24:27] offset:49152
  v_add_u32 v59, 73728, v59
  ds_write_b128 v59, v[24:27]
L_notab:
  s_mov_b64 exec, s[52:53]
  v_sub_f32 v20, 0, v16
  v_cvt_pk_bf16_f32 v21, v20, v18
  v_lshlrev_b32 v22, 16, v21
  v_and_b32 v23, 0xffff0000, v21
  v_sub_f32 v22, v20, v22
  v_sub_f32 v62, v18, v23
  v_cvt_pk_bf16_f32 v22, v22, v62
  v_mov_b32 v101, v21
  v_and_b32 v100, 0xffff, v21
  v_lshlrev_b32 v19, 16, v22
  v_or_b32 v100, v100, v19
  v_lshrrev_b32 v102, 16, v22
  v_mov_b32 v103, 0
  v_cmp_gt_u32 vcc, 32, v1
  s_nop 1
  v_cndmask_b32 v100, 0, v100, vcc
  v_cndmask_b32 v101, 0, v101, vcc
  v_cndmask_b32 v102, 0, v102, vcc
  s_waitcnt lgkmcnt(0)
  s_barrier
  s_lshl_b32 s42, s40, 1
  s_add_u32 s42, s42, s32
  s_mul_i32 s43, s31, 12
  s_add_u32 s43, s43, s42
  s_lshl_b32 s43, s43, 11
  s_add_u32 s50, s43, 65536
  v_add_u32 v56, s50, v9
  ds_read_b128 v[96:99], v56
  v_lshlrev_b32 v5, 2, v1
  v_add_u32 v8, s50, v15
  s_waitcnt lgkmcnt(0)
  v_mfma_f32_32x32x16_bf16 v[80:95], v[96:99], v[100:103], v[80:95]
  s_mov_b32 s40, s41
  s_mov_b32 s34, 1
  s_lshl_b32 s58, s33, 1
  s_mul_i32 s59, s31, 12
  s_add_u32 s59, s59, s32
  s_lshl_b32 s59, s59, 11
  s_add_u32 s59, s59, 65536
  .p2align 3
L_A:
  s_waitcnt vmcnt(3) lgkmcnt(4)
  s_barrier
  v_mfma_f32_32x32x16_bf16 v[64:79], v[32:35], v[112:115], 0
  ds_read_b64_tr_b16 v[48:49], v6 offset:0
  ds_read_b64_tr_b16 v[50:51], v6 offset:512
  s_and_b32 m0, s36, 65535
  s_add_u32 s36, s36, 8192
  buffer_load_dwordx4 v2, s[8:11], s38 offen lds
  s_add_u32 s38, s38, s39
  v_mfma_f32_32x32x16_bf16 v[64:79], v[36:39], v[116:119], v[64:79]
  v_mul_f32 v16, v80, v80
  v_mul_f32 v17, v81, v81
  v_mul_f32 v18, v82, v82
  v_mul_f32 v19, v83, v83
  v_fma_f32 v16, v16, v11, v10
  v_fma_f32 v17, v17, v11, v10
  ds_read_b64_tr_b16 v[52:53], v6 offset:2048
  ds_read_b64_tr_b16 v[54:55], v6 offset:2560
  s_waitcnt lgkmcnt(4)
  v_mfma_f32_32x32x16_bf16 v[64:79], v[40:43], v[120:123], v[64:79]
  v_fma_f32 v18, v18, v11, v10
  v_fma_f32 v19, v19, v11, v10
  v_mul_f32 v16, v80, v16
  v_mul_f32 v17, v81, v17
  v_mul_f32 v18, v82, v18
  ds_read_b64_tr_b16 v[32:33], v6 offset:4096
  ds_read_b64_tr_b16 v[34:35], v6 offset:4608
  v_mfma_f32_32x32x16_bf16 v[64:79], v[44:47], v[124:127], v[64:79]
  v_mul_f32 v19, v83, v19
  v_exp_f32 v16, v16
  v_exp_f32 v17, v17
  ds_read_b64_tr_b16 v[36:37], v6 offset:6144
  ds_read_b64_tr_b16 v[38:39], v6 offset:6656
  v_add_u16 v6, 8192, v6
  s_waitcnt lgkmcnt(4)
  v_mfma_f32_32x32x16_bf16 v[64:79], v[48:51], v[128:131], v[64:79]
  v_exp_f32 v18, v18
  v_exp_f32 v19, v19
  v_add_f32 v16, 1.0, v16
  ds_read_b64_tr_b16 v[40:41], v6 offset:0
  ds_read_b64_tr_b16 v[42:43], v6 offset:512
  s_and_b32 m0, s36, 65535
  s_add_u32 s36, s36, 8192
  buffer_load_dwordx4 v2, s[8:11], s38 offen lds
  s_add_u32 s38, s38, s39
  v_mfma_f32_32x32x16_bf16 v[64:79], v[52:55], v[132:135], v[64:79]
  v_add_f32 v17, 1.0, v17
  v_add_f32 v18, 1.0, v18
  v_add_f32 v19, 1.0, v19
  v_rcp_f32 v16, v16
  ds_read_b64_tr_b16 v[44:45], v6 offset:2048
  ds_read_b64_tr_b16 v[46:47], v6 offset:2560
  s_waitcnt lgkmcnt(4)
  v_mfma_f32_32x32x16_bf16 v[64:79], v[32:35], v[136:139], v[64:79]
  v_rcp_f32 v17, v17
  v_rcp_f32 v18, v18
  v_mul_f32 v16, v80, v16
  ds_read_b64_tr_b16 v[48:49], v6 offset:4096
  ds_read_b64_tr_b16 v[50:51], v6 offset:4608
  ds_read_b64_tr_b16 v[52:53], v6 offset:6144
  ds_read_b64_tr_b16 v[54:55], v6 offset:6656
  v_add_u16 v6, 8192, v6
  v_mfma_f32_32x32x16_bf16 v[64:79], v[36:39], v[140:143], v[64:79]
  s_waitcnt vmcnt(3) lgkmcnt(4)
  s_barrier
  v_mfma_f32_32x32x16_bf16 v[64:79], v[40:43], v[144:147], v[64:79]
  v_rcp_f32 v19, v19
  v_mul_f32 v17, v81, v17
  v_cvt_pk_bf16_f32 v24, v16, v17
  v_mul_f32 v18, v82, v18
  ds_read_b64_tr_b16 v[32:33], v6 offset:0
  ds_read_b64_tr_b16 v[34:35], v6 offset:512
  s_and_b32 m0, s36, 65535
  s_add_u32 s36, s36, 8192
  buffer_load_dwordx4 v2, s[8:11], s38 offen lds
  s_add_u32 s38, s38, s39
  v_mfma_f32_32x32x16_bf16 v[64:79], v[44:47], v[148:151], v[64:79]
  v_mul_f32 v19, v83, v19
  v_cvt_pk_bf16_f32 v25, v18, v19
  v_mul_f32 v20, v84, v84
  v_mul_f32 v21, v85, v85
  v_mul_f32 v22, v86, v86
  ds_read_b64_tr_b16 v[36:37], v6 offset:2048
  ds_read_b64_tr_b16 v[38:39], v6 offset:2560
  s_waitcnt lgkmcnt(4)
  v_mfma_f32_32x32x16_bf16 v[64:79], v[48:51], v[152:155], v[64:79]
  v_mul_f32 v23, v87, v87
  v_fma_f32 v20, v20, v11, v10
  v_fma_f32 v21, v21, v11, v10
  v_fma_f32 v22, v22, v11, v10
  v_fma_f32 v23, v23, v11, v10
  ds_read_b64_tr_b16 v[40:41], v6 offset:4096
  ds_read_b64_tr_b16 v[42:43], v6 offset:4608
  s_add_u32 s41, s40, 1
  s_cmp_eq_u32 s41, 6
  s_cselect_b32 s41, 0, s41
  s_lshl_b32 s42, s41, 7
  s_add_u32 s38, s42, s58
  s_cmp_eq_u32 s34, 5
  s_cbranch_scc1 L_A_sw
L_A_swret:
  v_mfma_f32_32x32x16_bf16 v[64:79], v[52:55], v[156:159], v[64:79]
  v_mul_f32 v20, v84, v20
  v_mul_f32 v21, v85, v21
  v_mul_f32 v22, v86, v22
  v_mul_f32 v23, v87, v23
  v_mul_f32 v16, v88, v88
  ds_read_b64_tr_b16 v[44:45], v6 offset:6144
  ds_read_b64_tr_b16 v[46:47], v6 offset:6656
  v_add_u16 v6, 8192, v6
  s_waitcnt lgkmcnt(4)
  v_mfma_f32_32x32x16_bf16 v[64:79], v[32:35], v[160:163], v[64:79]
  v_exp_f32 v20, v20
  v_exp_f32 v21, v21
  v_mul_f32 v17, v89, v89
  v_add_f32 v20, 1.0, v20
  ds_read_b64_tr_b16 v[48:49], v6 offset:0
  ds_read_b64_tr_b16 v[50:51], v6 offset:512
  s_and_b32 m0, s36, 65535
  s_add_u32 s36, s36, 8192
  buffer_load_dwordx4 v2, s[8:11], s38 offen lds
  s_add_u32 s38, s38, s39
  v_mfma_f32_32x32x16_bf16 v[64:79], v[36:39], v[164:167], v[64:79]
  v_exp_f32 v22, v22
  v_exp_f32 v23, v23
  v_add_f32 v21, 1.0, v21
  ds_read_b64_tr_b16 v[52:53], v6 offset:2048
  ds_read_b64_tr_b16 v[54:55], v6 offset:2560
  s_waitcnt lgkmcnt(4)
  v_mfma_f32_32x32x16_bf16 v[64:79], v[40:43], v[168:171], v[64:79]
  v_add_f32 v22, 1.0, v22
  v_add_f32 v23, 1.0, v23
  v_rcp_f32 v20, v20
  v_mul_f32 v18, v90, v90
  ds_read_b64_tr_b16 v[32:33], v6 offset:4096
  ds_read_b64_tr_b16 v[34:35], v6 offset:4608
  ds_read_b64_tr_b16 v[36:37], v6 offset:6144
  ds_read_b64_tr_b16 v[38:39], v6 offset:6656
  v_add_u16 v6, 8192, v6
  v_mfma_f32_32x32x16_bf16 v[64:79], v[44:47], v[172:175], v[64:79]
  s_waitcnt vmcnt(3) lgkmcnt(4)
  s_barrier
  v_mfma_f32_32x32x16_bf16 v[64:79], v[48:51], v[176:179], v[64:79]
  v_rcp_f32 v21, v21
  v_rcp_f32 v22, v22
  v_mul_f32 v20, v84, v20
  ds_read_b64_tr_b16 v[40:41], v6 offset:0
  ds_read_b64_tr_b16 v[42:43], v6 offset:512
  s_and_b32 m0, s36, 65535
  s_add_u32 s36, s36, 8192
  buffer_load_dwordx4 v2, s[8:11], s38 offen lds
  s_add_u32 s38, s38, s39
  v_mfma_f32_32x32x16_bf16 v[64:79], v[52:55], v[180:183], v[64:79]
  v_rcp_f32 v23, v23
  v_mul_f32 v21, v85, v21
  v_cvt_pk_bf16_f32 v26, v20, v21
  v_mul_f32 v22, v86, v22
  ds_read_b64_tr_b16 v[44:45], v6 offset:2048
  ds_read_b64_tr_b16 v[46:47], v6 offset:2560
  s_waitcnt lgkmcnt(4)
  v_mfma_f32_32x32x16_bf16 v[64:79], v[32:35], v[184:187], v[64:79]
  v_mul_f32 v23, v87, v23
  v_cvt_pk_bf16_f32 v27, v22, v23
  v_mul_f32 v19, v91, v91
  v_fma_f32 v16, v16, v11, v10
  v_fma_f32 v17, v17, v11, v10
  ds_read_b64_tr_b16 v[48:49], v6 offset:4096
  ds_read_b64_tr_b16 v[50:51], v6 offset:4608
  v_mfma_f32_32x32x16_bf16 v[64:79], v[36:39], v[188:191], v[64:79]
  v_fma_f32 v18, v18, v11, v10
  v_fma_f32 v19, v19, v11, v10
  v_mul_f32 v16, v88, v16
  v_mul_f32 v17, v89, v17
  v_mul_f32 v18, v90, v18
  ds_read_b64_tr_b16 v[52:53], v6 offset:6144
  ds_read_b64_tr_b16 v[54:55], v6 offset:6656
  v_add_u16 v6, 8192, v6
  s_waitcnt lgkmcnt(4)
  v_mfma_f32_32x32x16_bf16 v[64:79], v[40:43], v[192:195], v[64:79]
  v_mul_f32 v19, v91, v19
  v_exp_f32 v16, v16
  v_exp_f32 v17, v17
  ds_read_b64_tr_b16 v[32:33], v6 offset:0
  ds_read_b64_tr_b16 v[34:35], v6 offset:512
  s_and_b32 m0, s36, 65535
  s_add_u32 s36, s36, 8192
  buffer_load_dwordx4 v2, s[8:11], s38 offen lds
  s_add_u32 s38, s38, s39
  v_mfma_f32_32x32x16_bf16 v[64:79], v[44:47], v[196:199], v[64:79]
  v_exp_f32 v18, v18
  v_exp_f32 v19, v19
  v_add_f32 v16, 1.0, v16
  ds_read_b64_tr_b16 v[36:37], v6 offset:2048
  ds_read_b64_tr_b16 v[38:39], v6 offset:2560
  s_lshl_b32 s42, s40, 12
  s_add_u32 s50, s59, s42
  s_waitcnt lgkmcnt(4)
  v_mfma_f32_32x32x16_bf16 v[64:79], v[48:51], v[200:203], v[64:79]
  v_add_f32 v17, 1.0, v17
  v_add_f32 v18, 1.0, v18
  v_add_f32 v19, 1.0, v19
  v_rcp_f32 v16, v16
  ds_read_b64_tr_b16 v[40:41], v6 offset:4096
  ds_read_b64_tr_b16 v[42:43], v6 offset:4608
  ds_read_b64_tr_b16 v[44:45], v6 offset:6144
  ds_read_b64_tr_b16 v[46:47], v6 offset:6656
  v_add_u16 v6, 8192, v6
  v_mfma_f32_32x32x16_bf16 v[64:79], v[52:55], v[204:207], v[64:79]
  s_waitcnt vmcnt(3) lgkmcnt(4)
  s_barrier
  v_mfma_f32_32x32x16_bf16 v[64:79], v[32:35], v[208:211], v[64:79]
  v_rcp_f32 v17, v17
  v_rcp_f32 v18, v18
  v_mul_f32 v16, v88, v16
  v_mul_f32 v17, v89, v17
  ds_read_b64_tr_b16 v[48:49], v6 offset:0
  ds_read_b64_tr_b16 v[50:51], v6 offset:512
  s_and_b32 m0, s36, 65535
  s_add_u32 s36, s36, 8192
  buffer_load_dwordx4 v2, s[8:11], s38 offen lds
  s_add_u32 s38, s38, s39
  v_mfma_f32_32x32x16_bf16 v[64:79], v[36:39], v[212:215], v[64:79]
  v_cvt_pk_bf16_f32 v28, v16, v17
  v_rcp_f32 v19, v19
  v_mul_f32 v18, v90, v18
  v_mul_f32 v20, v92, v92
  ds_read_b64_tr_b16 v[52:53], v6 offset:2048
  ds_read_b64_tr_b16 v[54:55], v6 offset:2560
  s_waitcnt lgkmcnt(4)
  v_mfma_f32_32x32x16_bf16 v[64:79], v[40:43], v[216:219], v[64:79]
  v_mul_f32 v19, v91, v19
  v_cvt_pk_bf16_f32 v29, v18, v19
  v_mul_f32 v21, v93, v93
  v_mul_f32 v22, v94, v94
  v_mul_f32 v23, v95, v95
  ds_read_b64_tr_b16 v[32:33], v6 offset:4096
  ds_read_b64_tr_b16 v[34:35], v6 offset:4608
  v_mfma_f32_32x32x16_bf16 v[64:79], v[44:47], v[220:223], v[64:79]
  v_fma_f32 v20, v20, v11, v10
  v_fma_f32 v21, v21, v11, v10
  v_fma_f32 v22, v22, v11, v10
  v_fma_f32 v23, v23, v11, v10
  v_mul_f32 v20, v92, v20
  ds_read_b64_tr_b16 v[36:37], v6 offset:6144
  ds_read_b64_tr_b16 v[38:39], v6 offset:6656
  v_add_u16 v6, 8192, v6
  s_waitcnt lgkmcnt(4)
  v_mfma_f32_32x32x16_bf16 v[64:79], v[48:51], v[224:227], v[64:79]
  v_mul_f32 v21, v93, v21
  v_mul_f32 v22, v94, v22
  v_mul_f32 v23, v95, v23
  v_exp_f32 v20, v20
  ds_read_b64_tr_b16 v[40:41], v6 offset:0
  ds_read_b64_tr_b16 v[42:43], v6 offset:512
  s_and_b32 m0, s36, 65535
  s_add_u32 s36, s36, 8192
  buffer_load_dwordx4 v2, s[8:11], s38 offen lds
  s_add_u32 s38, s38, s39
  v_mfma_f32_32x32x16_bf16 v[64:79], v[52:55], v[228:231], v[64:79]
  v_exp_f32 v21, v21
  v_exp_f32 v22, v22
  v_add_f32 v20, 1.0, v20
  ds_read_b64_tr_b16 v[44:45], v6 offset:2048
  ds_read_b64_tr_b16 v[46:47], v6 offset:2560
  s_waitcnt lgkmcnt(4)
  v_mfma_f32_32x32x16_bf16 v[64:79], v[32:35], v[232:235], v[64:79]
  v_exp_f32 v23, v23
  v_add_f32 v21, 1.0, v21
  v_add_f32 v22, 1.0, v22
  v_add_f32 v23, 1.0, v23
  ds_read_b64_tr_b16 v[48:49], v6 offset:4096
  ds_read_b64_tr_b16 v[50:51], v6 offset:4608
  ds_read_b64_tr_b16 v[52:53], v6 offset:6144
  ds_read_b64_tr_b16 v[54:55], v6 offset:6656
  v_add_u16 v6, 8192, v6
  v_mfma_f32_32x32x16_bf16 v[64:79], v[36:39], v[236:239], v[64:79]
  s_waitcnt vmcnt(4) lgkmcnt(4)
  s_barrier
  v_mfma_f32_32x32x16_bf16 v[64:79], v[40:43], v[240:243], v[64:79]
  v_rcp_f32 v20, v20
  v_rcp_f32 v21, v21
  ds_read_b64_tr_b16 v[32:33], v6 offset:0
  ds_read_b64_tr_b16 v[34:35], v6 offset:512
  s_and_b32 m0, s36, 65535
  s_add_u32 s36, s36, 8192
  buffer_load_dwordx4 v2, s[8:11], s38 offen lds
  s_add_u32 s38, s38, s39
  v_add_u32 v56, s50, v9
  ds_read_b128 v[96:99], v56
  v_mfma_f32_32x32x16_bf16 v[64:79], v[44:47], v[244:247], v[64:79]
  v_rcp_f32 v22, v22
  v_rcp_f32 v23, v23
  v_mul_f32 v20, v92, v20
  ds_read_b64_tr_b16 v[36:37], v6 offset:2048
  ds_read_b64_tr_b16 v[38:39], v6 offset:2560
  s_mov_b32 s40, s41
  s_add_u32 s34, s34, 1
  s_cmp_le_u32 s34, 5
  s_waitcnt lgkmcnt(5)
  v_mfma_f32_32x32x16_bf16 v[64:79], v[48:51], v[248:251], v[64:79]
  v_mul_f32 v21, v93, v21
  v_cvt_pk_bf16_f32 v30, v20, v21
  v_mul_f32 v22, v94, v22
  v_mul_f32 v23, v95, v23
  v_cvt_pk_bf16_f32 v31, v22, v23
  ds_read_b64_tr_b16 v[40:41], v6 offset:4096
  ds_read_b64_tr_b16 v[42:43], v6 offset:4608
  ds_read_b64_tr_b16 v[44:45], v6 offset:6144
  ds_read_b64_tr_b16 v[46:47], v6 offset:6656
  v_add_u16 v6, 8192, v6
  v_mfma_f32_32x32x16_bf16 v[80:95], v[52:55], v[252:255], v[64:79]
  s_waitcnt lgkmcnt(6)
  v_mfma_f32_32x32x16_bf16 v[80:95], v[96:99], v[100:103], v[80:95]
  ds_write_b128 v8, v[24:27] offset:0
  ds_write_b128 v8, v[28:31] offset:1024
  v_add_u32 v8, s50, v15
  s_cbranch_scc1 L_A
  s_branch L_A_done
L_A_sw:
  s_mov_b32 s8, s24
  s_mov_b32 s9, s25
  s_mov_b32 s10, 5308416
  s_mov_b32 s39, 73728
  s_mul_i32 s57, s33, 1152
  s_lshl_b32 s42, s49, 7
  s_add_u32 s38, s57, s42
  v_mov_b32 v2, v3
  s_branch L_A_swret
L_A_done:
  v_mov_b32 v59, 252
  buffer_load_dword v60, v59, s[16:19], 0 offen sc1
  s_nop 15
  v_mul_f32 v16, v80, v80
  v_mul_f32 v17, v81, v81
  v_mul_f32 v18, v82, v82
  v_mul_f32 v19, v83, v83
  v_fma_f32 v16, v16, v11, v10
  v_fma_f32 v17, v17, v11, v10
  v_fma_f32 v18, v18, v11, v10
  v_fma_f32 v19, v19, v11, v10
  v_mul_f32 v16, v80, v16
  v_mul_f32 v17, v81, v17
  v_mul_f32 v18, v82, v18
  v_mul_f32 v19, v83, v19
  v_exp_f32 v16, v16
  v_exp_f32 v17, v17
  v_exp_f32 v18, v18
  v_exp_f32 v19, v19
  v_add_f32 v16, 1.0, v16
  v_add_f32 v17, 1.0, v17
  v_add_f32 v18, 1.0, v18
  v_add_f32 v19, 1.0, v19
  v_rcp_f32 v16, v16
  v_rcp_f32 v17, v17
  v_rcp_f32 v18, v18
  v_rcp_f32 v19, v19
  v_mul_f32 v16, v80, v16
  v_mul_f32 v17, v81, v17
  v_mul_f32 v18, v82, v18
  v_mul_f32 v19, v83, v19
  v_cvt_pk_bf16_f32 v24, v16, v17
  v_cvt_pk_bf16_f32 v25, v18, v19
  v_mul_f32 v20, v84, v84
  v_mul_f32 v21, v85, v85
  v_mul_f32 v22, v86, v86
  v_mul_f32 v23, v87, v87
  v_fma_f32 v20, v20, v11, v10
  v_fma_f32 v21, v21, v11, v10
  v_fma_f32 v22, v22, v11, v10
  v_fma_f32 v23, v23, v11, v10
  v_mul_f32 v20, v84, v20
  v_mul_f32 v21, v85, v21
  v_mul_f32 v22, v86, v22
  v_mul_f32 v23, v87, v23
  v_exp_f32 v20, v20
  v_exp_f32 v21, v21
  v_exp_f32 v22, v22
  v_exp_f32 v23, v23
  v_add_f32 v20, 1.0, v20
  v_add_f32 v21, 1.0, v21
  v_add_f32 v22, 1.0, v22
  v_add_f32 v23, 1.0, v23
  v_rcp_f32 v20, v20
  v_rcp_f32 v21, v21
  v_rcp_f32 v22, v22
  v_rcp_f32 v23, v23
  v_mul_f32 v20, v84, v20
  v_mul_f32 v21, v85, v21
  v_mul_f32 v22, v86, v22
  v_mul_f32 v23, v87, v23
  v_cvt_pk_bf16_f32 v26, v20, v21
  v_cvt_pk_bf16_f32 v27, v22, v23
  ds_write_b128 v8, v[24:27] offset:0
  v_mul_f32 v16, v88, v88
  v_mul_f32 v17, v89, v89
  v_mul_f32 v18, v90, v90
  v_mul_f32 v19, v91, v91
  v_fma_f32 v16, v16, v11, v10
  v_fma_f32 v17, v17, v11, v10
  v_fma_f32 v18, v18, v11, v10
  v_fma_f32 v19, v19, v11, v10
  v_mul_f32 v16, v88, v16
  v_mul_f32 v17, v89, v17
  v_mul_f32 v18, v90, v18
  v_mul_f32 v19, v91, v19
  v_exp_f32 v16, v16
  v_exp_f32 v17, v17
  v_exp_f32 v18, v18
  v_exp_f32 v19, v19
  v_add_f32 v16, 1.0, v16
  v_add_f32 v17, 1.0, v17
  v_add_f32 v18, 1.0, v18
  v_add_f32 v19, 1.0, v19
  v_rcp_f32 v16, v16
  v_rcp_f32 v17, v17
  v_rcp_f32 v18, v18
  v_rcp_f32 v19, v19
  v_mul_f32 v16, v88, v16
  v_mul_f32 v17, v89, v17
  v_mul_f32 v18, v90, v18
  v_mul_f32 v19, v91, v19
  v_cvt_pk_bf16_f32 v28, v16, v17
  v_cvt_pk_bf16_f32 v29, v18, v19
  v_mul_f32 v20, v92, v92
  v_mul_f32 v21, v93, v93
  v_mul_f32 v22, v94, v94
  v_mul_f32 v23, v95, v95
  v_fma_f32 v20, v20, v11, v10
  v_fma_f32 v21, v21, v11, v10
  v_fma_f32 v22, v22, v11, v10
  v_fma_f32 v23, v23, v11, v10
  v_mul_f32 v20, v92, v20
  v_mul_f32 v21, v93, v21
  v_mul_f32 v22, v94, v22
  v_mul_f32 v23, v95, v23
  v_exp_f32 v20, v20
  v_exp_f32 v21, v21
  v_exp_f32 v22, v22
  v_exp_f32 v23, v23
  v_add_f32 v20, 1.0, v20
  v_add_f32 v21, 1.0, v21
  v_add_f32 v22, 1.0, v22
  v_add_f32 v23, 1.0, v23
  v_rcp_f32 v20, v20
  v_rcp_f32 v21, v21
  v_rcp_f32 v22, v22
  v_rcp_f32 v23, v23
  v_mul_f32 v20, v92, v20
  v_mul_f32 v21, v93, v21
  v_mul_f32 v22, v94, v22
  v_mul_f32 v23, v95, v23
  v_cvt_pk_bf16_f32 v30, v20, v21
  v_cvt_pk_bf16_f32 v31, v22, v23
  ds_write_b128 v8, v[28:31] offset:1024
  s_waitcnt vmcnt(0) lgkmcnt(0)
  v_readfirstlane_b32 s90, v60
  s_barrier
  s_mul_i32 s42, s31, 24576
  s_add_u32 s42, s42, 65536
  v_add_u32 v56, s42, v15
  ds_read_b128 v[112:115], v56 offset:0
  ds_read_b128 v[116:119], v56 offset:1024
  ds_read_b128 v[120:123], v56 offset:2048
  ds_read_b128 v[124:127], v56 offset:3072
  ds_read_b128 v[128:131], v56 offset:4096
  ds_read_b128 v[132:135], v56 offset:5120
  ds_read_b128 v[136:139], v56 offset:6144
  ds_read_b128 v[140:143], v56 offset:7168
  ds_read_b128 v[144:147], v56 offset:8192
  ds_read_b128 v[148:151], v56 offset:9216
  ds_read_b128 v[152:155], v56 offset:10240
  ds_read_b128 v[156:159], v56 offset:11264
  ds_read_b128 v[160:163], v56 offset:12288
  ds_read_b128 v[164:167], v56 offset:13312
  ds_read_b128 v[168:171], v56 offset:14336
  ds_read_b128 v[172:175], v56 offset:15360
  ds_read_b128 v[176:179], v56 offset:16384
  ds_read_b128 v[180:183], v56 offset:17408
  ds_read_b128 v[184:187], v56 offset:18432
  ds_read_b128 v[188:191], v56 offset:19456
  ds_read_b128 v[192:195], v56 offset:20480
  ds_read_b128 v[196:199], v56 offset:21504
  ds_read_b128 v[200:203], v56 offset:22528
  ds_read_b128 v[204:207], v56 offset:23552
  v_sub_u16 v57, v6, v4
  v_add_u16 v57, v57, v7
  v_add_u16 v6, 0xe000, v57
  s_waitcnt lgkmcnt(0)
  ds_read_b64_tr_b16 v[32:33], v6 offset:0
  ds_read_b64_tr_b16 v[34:35], v6 offset:1024
  ds_read_b64_tr_b16 v[36:37], v6 offset:2048
  ds_read_b64_tr_b16 v[38:39], v6 offset:3072
  ds_read_b64_tr_b16 v[40:41], v6 offset:4096
  ds_read_b64_tr_b16 v[42:43], v6 offset:5120
  ds_read_b64_tr_b16 v[44:45], v6 offset:6144
  ds_read_b64_tr_b16 v[46:47], v6 offset:7168
  v_mov_b32 v6, v57
  s_lshl_b32 s42, s28, 2
  s_add_u32 s42, s42, s31
  s_mul_i32 s42, s42, 288
  s_add_u32 s42, s42, s29
  s_lshl_b32 s46, s42, 11
  s_add_u32 s46, s46, 0
  s_lshl_b32 s42, s32, 15
  s_add_u32 s46, s46, s42
  s_mov_b32 s45, 1073741824
  s_mov_b32 s40, s49
  s_add_u32 s42, s40, 1
  s_cmp_eq_u32 s42, 9
  s_cselect_b32 s42, 0, s42
  s_lshl_b32 s42, s42, 7
  s_add_u32 s38, s57, s42
  s_mov_b32 s34, 0
  .p2align 3
L_B:
  s_waitcnt vmcnt(5) lgkmcnt(4)
  s_barrier
  v_mfma_f32_32x32x16_bf16 v[64:79], v[32:35], v[112:115], 0
  ds_read_b64_tr_b16 v[48:49], v6 offset:0
  ds_read_b64_tr_b16 v[50:51], v6 offset:1024
  s_and_b32 m0, s36, 65535
  s_add_u32 s36, s36, 8192
  buffer_load_dwordx4 v2, s[8:11], s38 offen lds
  s_add_u32 s38, s38, s39
  v_mfma_f32_32x32x16_bf16 v[64:79], v[36:39], v[116:119], v[64:79]
  ds_read_b64_tr_b16 v[52:53], v6 offset:2048
  ds_read_b64_tr_b16 v[54:55], v6 offset:3072
  s_waitcnt lgkmcnt(4)
  v_mfma_f32_32x32x16_bf16 v[64:79], v[40:43], v[120:123], v[64:79]
  v_mul_f32 v80, v80, v12
  v_mul_f32 v81, v81, v12
  v_mul_f32 v82, v82, v12
  v_mul_f32 v83, v83, v12
  ds_read_b64_tr_b16 v[32:33], v6 offset:4096
  ds_read_b64_tr_b16 v[34:35], v6 offset:5120
  v_mfma_f32_32x32x16_bf16 v[64:79], v[44:47], v[124:127], v[64:79]
  v_mul_f32 v84, v84, v12
  v_mul_f32 v85, v85, v12
  v_mul_f32 v86, v86, v12
  v_mul_f32 v87, v87, v12
  ds_read_b64_tr_b16 v[36:37], v6 offset:6144
  ds_read_b64_tr_b16 v[38:39], v6 offset:7168
  v_add_u16 v6, 8192, v6
  s_waitcnt lgkmcnt(4)
  v_mfma_f32_32x32x16_bf16 v[64:79], v[48:51], v[128:131], v[64:79]
  ds_read_b64_tr_b16 v[40:41], v6 offset:0
  ds_read_b64_tr_b16 v[42:43], v6 offset:1024
  s_and_b32 m0, s36, 65535
  s_add_u32 s36, s36, 8192
  buffer_load_dwordx4 v2, s[8:11], s38 offen lds
  s_add_u32 s38, s38, s39
  v_mfma_f32_32x32x16_bf16 v[64:79], v[52:55], v[132:135], v[64:79]
  v_mul_f32 v88, v88, v12
  v_mul_f32 v89, v89, v12
  v_mul_f32 v90, v90, v12
  v_mul_f32 v91, v91, v12
  ds_read_b64_tr_b16 v[44:45], v6 offset:2048
  ds_read_b64_tr_b16 v[46:47], v6 offset:3072
  s_waitcnt lgkmcnt(4)
  v_mfma_f32_32x32x16_bf16 v[64:79], v[32:35], v[136:139], v[64:79]
  v_mul_f32 v92, v92, v12
  v_mul_f32 v93, v93, v12
  v_mul_f32 v94, v94, v12
  v_mul_f32 v95, v95, v12
  ds_read_b64_tr_b16 v[48:49], v6 offset:4096
  ds_read_b64_tr_b16 v[50:51], v6 offset:5120
  ds_read_b64_tr_b16 v[52:53], v6 offset:6144
  ds_read_b64_tr_b16 v[54:55], v6 offset:7168
  v_add_u16 v6, 8192, v6
  v_mfma_f32_32x32x16_bf16 v[64:79], v[36:39], v[140:143], v[64:79]
  s_waitcnt vmcnt(3) lgkmcnt(4)
  s_barrier
  v_mfma_f32_32x32x16_bf16 v[64:79], v[40:43], v[144:147], v[64:79]
  ds_read_b64_tr_b16 v[32:33], v6 offset:0
  ds_read_b64_tr_b16 v[34:35], v6 offset:1024
  s_and_b32 m0, s36, 65535
  s_add_u32 s36, s36, 8192
  buffer_load_dwordx4 v2, s[8:11], s38 offen lds
  s_add_u32 s38, s38, s39
  s_cmp_eq_u32 s34, 7
  s_cbranch_scc1 L_B_esig
L_B_esigret:
  v_mfma_f32_32x32x16_bf16 v[64:79], v[44:47], v[148:151], v[64:79]
  v_cvt_pk_bf16_f32 v24, v80, v81
  v_cvt_pk_bf16_f32 v25, v82, v83
  v_cvt_pk_bf16_f32 v26, v84, v85
  v_cvt_pk_bf16_f32 v27, v86, v87
  ds_read_b64_tr_b16 v[36:37], v6 offset:2048
  ds_read_b64_tr_b16 v[38:39], v6 offset:3072
  s_waitcnt lgkmcnt(4)
  v_mfma_f32_32x32x16_bf16 v[64:79], v[48:51], v[152:155], v[64:79]
  v_cvt_pk_bf16_f32 v28, v88, v89
  v_cvt_pk_bf16_f32 v29, v90, v91
  v_cvt_pk_bf16_f32 v30, v92, v93
  v_cvt_pk_bf16_f32 v31, v94, v95
  ds_read_b64_tr_b16 v[40:41], v6 offset:4096
  ds_read_b64_tr_b16 v[42:43], v6 offset:5120
  v_mfma_f32_32x32x16_bf16 v[64:79], v[52:55], v[156:159], v[64:79]
  ds_read_b64_tr_b16 v[44:45], v6 offset:6144
  ds_read_b64_tr_b16 v[46:47], v6 offset:7168
  v_add_u16 v6, 8192, v6
  s_waitcnt lgkmcnt(4)
  v_mfma_f32_32x32x16_bf16 v[64:79], v[32:35], v[160:163], v[64:79]
  ds_read_b64_tr_b16 v[48:49], v6 offset:0
  ds_read_b64_tr_b16 v[50:51], v6 offset:1024
  s_and_b32 m0, s36, 65535
  s_add_u32 s36, s36, 8192
  buffer_load_dwordx4 v2, s[8:11], s38 offen lds
  s_add_u32 s38, s38, s39
  v_mfma_f32_32x32x16_bf16 v[64:79], v[36:39], v[164:167], v[64:79]
  ds_read_b64_tr_b16 v[52:53], v6 offset:2048
  ds_read_b64_tr_b16 v[54:55], v6 offset:3072
  buffer_store_dwordx4 v[24:27], v15, s[12:15], s45 offen sc1
  s_waitcnt lgkmcnt(4)
  v_mfma_f32_32x32x16_bf16 v[64:79], v[40:43], v[168:171], v[64:79]
  ds_read_b64_tr_b16 v[32:33], v6 offset:4096
  ds_read_b64_tr_b16 v[34:35], v6 offset:5120
  buffer_store_dwordx4 v[28:31], v15, s[12:15], s45 offen offset:1024 sc1
  ds_read_b64_tr_b16 v[36:37], v6 offset:6144
  ds_read_b64_tr_b16 v[38:39], v6 offset:7168
  v_add_u16 v6, 8192, v6
  v_mfma_f32_32x32x16_bf16 v[64:79], v[44:47], v[172:175], v[64:79]
  s_waitcnt vmcnt(5) lgkmcnt(4)
  s_barrier
  v_mfma_f32_32x32x16_bf16 v[64:79], v[48:51], v[176:179], v[64:79]
  ds_read_b64_tr_b16 v[40:41], v6 offset:0
  ds_read_b64_tr_b16 v[42:43], v6 offset:1024
  s_and_b32 m0, s36, 65535
  s_add_u32 s36, s36, 8192
  buffer_load_dwordx4 v2, s[8:11], s38 offen lds
  s_add_u32 s38, s38, s39
  v_mfma_f32_32x32x16_bf16 v[64:79], v[52:55], v[180:183], v[64:79]
  ds_read_b64_tr_b16 v[44:45], v6 offset:2048
  ds_read_b64_tr_b16 v[46:47], v6 offset:3072
  s_add_u32 s41, s40, 1
  s_cmp_eq_u32 s41, 9
  s_cselect_b32 s41, 0, s41
  s_waitcnt lgkmcnt(4)
  v_mfma_f32_32x32x16_bf16 v[64:79], v[32:35], v[184:187], v[64:79]
  ds_read_b64_tr_b16 v[48:49], v6 offset:4096
  ds_read_b64_tr_b16 v[50:51], v6 offset:5120
  s_lshl_b32 s42, s40, 16
  s_add_u32 s45, s46, s42
  v_mfma_f32_32x32x16_bf16 v[64:79], v[36:39], v[188:191], v[64:79]
  ds_read_b64_tr_b16 v[52:53], v6 offset:6144
  ds_read_b64_tr_b16 v[54:55], v6 offset:7168
  v_add_u16 v6, 8192, v6
  s_waitcnt lgkmcnt(4)
  v_mfma_f32_32x32x16_bf16 v[64:79], v[40:43], v[192:195], v[64:79]
  ds_read_b64_tr_b16 v[32:33], v6 offset:0
  ds_read_b64_tr_b16 v[34:35], v6 offset:1024
  s_and_b32 m0, s36, 65535
  s_add_u32 s36, s36, 8192
  buffer_load_dwordx4 v2, s[8:11], s38 offen lds
  s_add_u32 s38, s38, s39
  v_mfma_f32_32x32x16_bf16 v[64:79], v[44:47], v[196:199], v[64:79]
  ds_read_b64_tr_b16 v[36:37], v6 offset:2048
  ds_read_b64_tr_b16 v[38:39], v6 offset:3072
  s_add_u32 s42, s41, 1
  s_cmp_eq_u32 s42, 9
  s_cselect_b32 s42, 0, s42
  s_lshl_b32 s42, s42, 7
  s_waitcnt lgkmcnt(4)
  v_mfma_f32_32x32x16_bf16 v[64:79], v[48:51], v[200:203], v[64:79]
  ds_read_b64_tr_b16 v[40:41], v6 offset:4096
  ds_read_b64_tr_b16 v[42:43], v6 offset:5120
  s_add_u32 s38, s57, s42
  s_mov_b32 s40, s41
  s_add_u32 s34, s34, 1
  s_cmp_lt_u32 s34, 9
  ds_read_b64_tr_b16 v[44:45], v6 offset:6144
  ds_read_b64_tr_b16 v[46:47], v6 offset:7168
  v_add_u16 v6, 8192, v6
  v_mfma_f32_32x32x16_bf16 v[80:95], v[52:55], v[204:207], v[64:79]
  s_cbranch_scc1 L_B
  s_branch L_B_fin
L_B_esig:
  s_cmp_eq_u32 s30, 0
  s_cbranch_scc0 L_B_esigret
L_B_esig_n:
  s_cmp_lg_u32 s90, 0
  s_cbranch_scc1 L_B_esig_go
  v_mov_b32 v59, 252
  buffer_load_dword v60, v59, s[16:19], 0 offen sc1
  s_waitcnt vmcnt(0)
  v_readfirstlane_b32 s90, v60
  s_nop 3
  s_branch L_B_esig_n
L_B_esig_go:
  s_lshl_b32 s42, s28, 7
  s_add_u32 s42, s42, 38109184
  s_lshl_b32 s43, s29, 2
  v_mov_b32 v59, s43
  v_mov_b32 v60, s90
  s_mov_b64 exec, 1
  buffer_store_dword v60, v59, s[12:15], s42 offen sc0 sc1
  s_mov_b64 exec, -1
  s_branch L_B_esigret
L_B_fin:
  s_nop 15
  v_mul_f32 v80, v80, v12
  v_mul_f32 v81, v81, v12
  v_mul_f32 v82, v82, v12
  v_mul_f32 v83, v83, v12
  v_mul_f32 v84, v84, v12
  v_mul_f32 v85, v85, v12
  v_mul_f32 v86, v86, v12
  v_mul_f32 v87, v87, v12
  v_mul_f32 v88, v88, v12
  v_mul_f32 v89, v89, v12
  v_mul_f32 v90, v90, v12
  v_mul_f32 v91, v91, v12
  v_mul_f32 v92, v92, v12
  v_mul_f32 v93, v93, v12
  v_mul_f32 v94, v94, v12
  v_mul_f32 v95, v95, v12
  v_cvt_pk_bf16_f32 v24, v80, v81
  v_cvt_pk_bf16_f32 v25, v82, v83
  v_cvt_pk_bf16_f32 v26, v84, v85
  v_cvt_pk_bf16_f32 v27, v86, v87
  v_cvt_pk_bf16_f32 v28, v88, v89
  v_cvt_pk_bf16_f32 v29, v90, v91
  v_cvt_pk_bf16_f32 v30, v92, v93
  v_cvt_pk_bf16_f32 v31, v94, v95
  buffer_store_dwordx4 v[24:27], v15, s[12:15], s45 offen sc1
  buffer_store_dwordx4 v[28:31], v15, s[12:15], s45 offen offset:1024 sc1
  s_waitcnt vmcnt(0) lgkmcnt(0)
  s_mov_b32 s62, s29
  s_load_dwordx2 s[4:5], s[0:1], 72
  s_load_dwordx2 s[20:21], s[0:1], 56
  s_mov_b64 exec, -1
  v_mov_b32 v56, 252
L_fm_poll:
  buffer_load_dword v57, v56, s[16:19], 0 offen sc1
  s_waitcnt vmcnt(0)
  v_readfirstlane_b32 s52, v57
  s_nop 3
  s_cmp_eq_u32 s52, 0
  s_cbranch_scc1 L_fm_poll
  s_barrier
  s_lshl_b32 s53, s28, 7
  s_add_u32 s53, s53, 38105088
  s_cmp_eq_u32 s30, 0
  s_cbranch_scc0 L_fm_nosig
  s_lshl_b32 s42, s62, 2
  v_mov_b32 v56, s42
  v_mov_b32 v57, s52
  s_mov_b64 exec, 1
  buffer_store_dword v57, v56, s[12:15], s53 offen sc0 sc1
  s_mov_b64 exec, -1
L_fm_nosig:
  s_waitcnt lgkmcnt(0)
  s_mov_b32 s6, 2359296
  s_mov_b32 s7, 0x00020000
  s_mov_b32 s22, 1152
  s_mov_b32 s23, 0x00020000
  v_mov_b32 v34, 0x00003f80
  v_mov_b32 v35, 0x3f800000
  s_lshr_b32 s63, s62, 2
  s_and_b32 s60, s62, 3
  s_lshr_b32 s61, s30, 2
  s_mul_i32 s61, s61, 3
  s_add_u32 s61, s61, s63
  s_add_u32 s78, s49, s61
  s_cmp_ge_u32 s78, 9
  s_cselect_b32 s54, 9, 0
  s_sub_u32 s78, s78, s54
  s_lshl_b32 s78, s78, 1
  s_lshr_b32 s54, s30, 1
  s_and_b32 s54, s54, 1
  s_add_u32 s78, s78, s54
  s_mul_i32 s54, s60, 18
  s_add_u32 s78, s78, s54
  s_lshl_b32 s78, s78, 1
  s_and_b32 s54, s30, 1
  s_add_u32 s78, s78, s54
  s_add_u32 s79, s53, 4096
  s_cmp_eq_u32 s30, 0
  s_cbranch_scc0 L_fe_done
  v_min_u32 v56, 11, v1
  v_add_u32 v56, 0, v56
  v_lshlrev_b32 v56, 2, v56
L_fe_wait:
  buffer_load_dword v57, v56, s[12:15], s79 offen sc0 sc1
  s_waitcnt vmcnt(0)
  v_cmp_ne_u32 vcc, s52, v57
  s_nop 4
  s_cmp_eq_u64 vcc, 0
  s_cbranch_scc1 L_fe_ok
  s_sleep 1
  s_branch L_fe_wait
L_fe_ok:
L_fe_done:
  s_barrier
  s_lshr_b32 s54, s78, 1
  s_and_b32 s55, s78, 1
  s_mul_i32 s56, s28, 72
  s_add_u32 s56, s56, s54
  s_lshl_b32 s57, s56, 15
  s_lshl_b32 s58, s55, 10
  s_add_u32 s57, s57, s58
  s_add_u32 s70, s57, 0
  s_mul_i32 s58, s54, 3641
  s_lshr_b32 s72, s58, 16
  s_mul_i32 s59, s72, 18
  s_sub_u32 s59, s54, s59
  s_lshl_b32 s59, s59, 5
  s_lshl_b32 s55, s55, 4
  s_add_u32 s71, s59, s55
  s_mov_b32 s57, s70
  buffer_load_dwordx4 v[64:67], v15, s[12:15], s57 offen sc0 sc1
  s_add_u32 s57, s57, 2048
  buffer_load_dwordx4 v[68:71], v15, s[12:15], s57 offen sc0 sc1
  s_add_u32 s57, s57, 2048
  buffer_load_dwordx4 v[72:75], v15, s[12:15], s57 offen sc0 sc1
  s_add_u32 s57, s57, 2048
  buffer_load_dwordx4 v[76:79], v15, s[12:15], s57 offen sc0 sc1
  s_add_u32 s57, s57, 2048
  buffer_load_dwordx4 v[80:83], v15, s[12:15], s57 offen sc0 sc1
  s_add_u32 s57, s57, 2048
  buffer_load_dwordx4 v[84:87], v15, s[12:15], s57 offen sc0 sc1
  s_add_u32 s57, s57, 2048
  buffer_load_dwordx4 v[88:91], v15, s[12:15], s57 offen sc0 sc1
  s_add_u32 s57, s57, 2048
  buffer_load_dwordx4 v[92:95], v15, s[12:15], s57 offen sc0 sc1
  s_add_u32 s57, s57, 2048
  buffer_load_dwordx4 v[96:99], v15, s[12:15], s57 offen sc0 sc1
  s_add_u32 s57, s57, 2048
  buffer_load_dwordx4 v[100:103], v15, s[12:15], s57 offen sc0 sc1
  s_add_u32 s57, s57, 2048
  buffer_load_dwordx4 v[104:107], v15, s[12:15], s57 offen sc0 sc1
  s_add_u32 s57, s57, 2048
  buffer_load_dwordx4 v[108:111], v15, s[12:15], s57 offen sc0 sc1
  v_lshrrev_b32 v112, 5, v1
  v_lshlrev_b32 v113, 2, v112
  v_add_u32 v113, s71, v113
  v_lshlrev_b32 v113, 1, v113
  buffer_load_dwordx2 v[114:115], v113, s[20:23], 0 offen
  buffer_load_dwordx2 v[116:117], v113, s[20:23], 0 offen offset:16
  v_lshrrev_b32 v118, 4, v9
  s_lshl_b32 s56, s28, 7
  s_lshl_b32 s58, s72, 5
  s_add_u32 s56, s56, s58
  v_add_u32 v118, s56, v118
  v_mul_u32_u24 v121, 1152, v118
  v_lshlrev_b32 v119, 4, v112
  v_add_u32 v121, v121, v119
  s_lshl_b32 s59, s71, 1
  v_add_u32 v121, s59, v121
  v_lshlrev_b32 v119, 2, v118
  s_cmp_eq_u32 s30, 0
  s_cbranch_scc0 L_f1_done
  v_min_u32 v56, 11, v1
  v_add_u32 v56, 0, v56
  v_lshlrev_b32 v56, 2, v56
L_f1_wait:
  buffer_load_dword v57, v56, s[12:15], s53 offen sc0 sc1
  s_waitcnt vmcnt(0)
  v_cmp_ne_u32 vcc, s52, v57
  s_nop 4
  s_cmp_eq_u64 vcc, 0
  s_cbranch_scc1 L_f1_ok
  s_sleep 1
  s_branch L_f1_wait
L_f1_ok:
L_f1_done:
  s_barrier
  s_cmp_lt_u32 s30, 4
  s_cbranch_scc0 L_f_one
  s_add_u32 s61, s63, 6
  s_add_u32 s78, s49, s61
  s_cmp_ge_u32 s78, 9
  s_cselect_b32 s54, 9, 0
  s_sub_u32 s78, s78, s54
  s_lshl_b32 s78, s78, 1
  s_lshr_b32 s54, s30, 1
  s_and_b32 s54, s54, 1
  s_add_u32 s78, s78, s54
  s_mul_i32 s54, s60, 18
  s_add_u32 s78, s78, s54
  s_lshl_b32 s78, s78, 1
  s_and_b32 s54, s30, 1
  s_add_u32 s78, s78, s54
  s_lshr_b32 s54, s78, 1
  s_and_b32 s55, s78, 1
  s_mul_i32 s56, s28, 72
  s_add_u32 s56, s56, s54
  s_lshl_b32 s57, s56, 15
  s_lshl_b32 s58, s55, 10
  s_add_u32 s57, s57, s58
  s_add_u32 s74, s57, 0
  s_mul_i32 s58, s54, 3641
  s_lshr_b32 s76, s58, 16
  s_mul_i32 s59, s76, 18
  s_sub_u32 s59, s54, s59
  s_lshl_b32 s59, s59, 5
  s_lshl_b32 s55, s55, 4
  s_add_u32 s75, s59, s55
  s_mov_b32 s57, s74
  buffer_load_dwordx4 v[140:143], v15, s[12:15], s57 offen sc0 sc1
  s_add_u32 s57, s57, 2048
  buffer_load_dwordx4 v[144:147], v15, s[12:15], s57 offen sc0 sc1
  s_add_u32 s57, s57, 2048
  buffer_load_dwordx4 v[148:151], v15, s[12:15], s57 offen sc0 sc1
  s_add_u32 s57, s57, 2048
  buffer_load_dwordx4 v[152:155], v15, s[12:15], s57 offen sc0 sc1
  s_add_u32 s57, s57, 2048
  buffer_load_dwordx4 v[156:159], v15, s[12:15], s57 offen sc0 sc1
  s_add_u32 s57, s57, 2048
  buffer_load_dwordx4 v[160:163], v15, s[12:15], s57 offen sc0 sc1
  s_add_u32 s57, s57, 2048
  buffer_load_dwordx4 v[164:167], v15, s[12:15], s57 offen sc0 sc1
  s_add_u32 s57, s57, 2048
  buffer_load_dwordx4 v[168:171], v15, s[12:15], s57 offen sc0 sc1
  s_add_u32 s57, s57, 2048
  buffer_load_dwordx4 v[172:175], v15, s[12:15], s57 offen sc0 sc1
  s_add_u32 s57, s57, 2048
  buffer_load_dwordx4 v[176:179], v15, s[12:15], s57 offen sc0 sc1
  s_add_u32 s57, s57, 2048
  buffer_load_dwordx4 v[180:183], v15, s[12:15], s57 offen sc0 sc1
  s_add_u32 s57, s57, 2048
  buffer_load_dwordx4 v[184:187], v15, s[12:15], s57 offen sc0 sc1
  v_lshrrev_b32 v188, 5, v1
  v_lshlrev_b32 v189, 2, v188
  v_add_u32 v189, s75, v189
  v_lshlrev_b32 v189, 1, v189
  buffer_load_dwordx2 v[190:191], v189, s[20:23], 0 offen
  buffer_load_dwordx2 v[192:193], v189, s[20:23], 0 offen offset:16
  v_lshrrev_b32 v194, 4, v9
  s_lshl_b32 s56, s28, 7
  s_lshl_b32 s58, s76, 5
  s_add_u32 s56, s56, s58
  v_add_u32 v194, s56, v194
  v_mul_u32_u24 v197, 1152, v194
  v_lshlrev_b32 v195, 4, v188
  v_add_u32 v197, v197, v195
  s_lshl_b32 s59, s75, 1
  v_add_u32 v197, s59, v197
  v_lshlrev_b32 v195, 2, v194
  s_waitcnt vmcnt(27)
  v_lshlrev_b32 v124, 16, v64
  v_and_b32 v125, 0xffff0000, v64
  v_lshlrev_b32 v126, 16, v65
  v_and_b32 v127, 0xffff0000, v65
  v_lshlrev_b32 v128, 16, v66
  v_and_b32 v129, 0xffff0000, v66
  v_lshlrev_b32 v130, 16, v67
  v_and_b32 v131, 0xffff0000, v67
  s_nop 1
  s_waitcnt vmcnt(26)
  v_dot2c_f32_bf16 v124, v34, v68
  v_dot2c_f32_bf16 v125, v35, v68
  v_dot2c_f32_bf16 v126, v34, v69
  v_dot2c_f32_bf16 v127, v35, v69
  v_dot2c_f32_bf16 v128, v34, v70
  v_dot2c_f32_bf16 v129, v35, v70
  v_dot2c_f32_bf16 v130, v34, v71
  v_dot2c_f32_bf16 v131, v35, v71
  s_waitcnt vmcnt(25)
  v_dot2c_f32_bf16 v124, v34, v72
  v_dot2c_f32_bf16 v125, v35, v72
  v_dot2c_f32_bf16 v126, v34, v73
  v_dot2c_f32_bf16 v127, v35, v73
  v_dot2c_f32_bf16 v128, v34, v74
  v_dot2c_f32_bf16 v129, v35, v74
  v_dot2c_f32_bf16 v130, v34, v75
  v_dot2c_f32_bf16 v131, v35, v75
  s_waitcnt vmcnt(24)
  v_dot2c_f32_bf16 v124, v34, v76
  v_dot2c_f32_bf16 v125, v35, v76
  v_dot2c_f32_bf16 v126, v34, v77
  v_dot2c_f32_bf16 v127, v35, v77
  v_dot2c_f32_bf16 v128, v34, v78
  v_dot2c_f32_bf16 v129, v35, v78
  v_dot2c_f32_bf16 v130, v34, v79
  v_dot2c_f32_bf16 v131, v35, v79
  s_waitcnt vmcnt(23)
  v_dot2c_f32_bf16 v124, v34, v80
  v_dot2c_f32_bf16 v125, v35, v80
  v_dot2c_f32_bf16 v126, v34, v81
  v_dot2c_f32_bf16 v127, v35, v81
  v_dot2c_f32_bf16 v128, v34, v82
  v_dot2c_f32_bf16 v129, v35, v82
  v_dot2c_f32_bf16 v130, v34, v83
  v_dot2c_f32_bf16 v131, v35, v83
  s_waitcnt vmcnt(22)
  v_dot2c_f32_bf16 v124, v34, v84
  v_dot2c_f32_bf16 v125, v35, v84
  v_dot2c_f32_bf16 v126, v34, v85
  v_dot2c_f32_bf16 v127, v35, v85
  v_dot2c_f32_bf16 v128, v34, v86
  v_dot2c_f32_bf16 v129, v35, v86
  v_dot2c_f32_bf16 v130, v34, v87
  v_dot2c_f32_bf16 v131, v35, v87
  s_waitcnt vmcnt(21)
  v_dot2c_f32_bf16 v124, v34, v88
  v_dot2c_f32_bf16 v125, v35, v88
  v_dot2c_f32_bf16 v126, v34, v89
  v_dot2c_f32_bf16 v127, v35, v89
  v_dot2c_f32_bf16 v128, v34, v90
  v_dot2c_f32_bf16 v129, v35, v90
  v_dot2c_f32_bf16 v130, v34, v91
  v_dot2c_f32_bf16 v131, v35, v91
  s_waitcnt vmcnt(20)
  v_dot2c_f32_bf16 v124, v34, v92
  v_dot2c_f32_bf16 v125, v35, v92
  v_dot2c_f32_bf16 v126, v34, v93
  v_dot2c_f32_bf16 v127, v35, v93
  v_dot2c_f32_bf16 v128, v34, v94
  v_dot2c_f32_bf16 v129, v35, v94
  v_dot2c_f32_bf16 v130, v34, v95
  v_dot2c_f32_bf16 v131, v35, v95
  s_waitcnt vmcnt(19)
  v_dot2c_f32_bf16 v124, v34, v96
  v_dot2c_f32_bf16 v125, v35, v96
  v_dot2c_f32_bf16 v126, v34, v97
  v_dot2c_f32_bf16 v127, v35, v97
  v_dot2c_f32_bf16 v128, v34, v98
  v_dot2c_f32_bf16 v129, v35, v98
  v_dot2c_f32_bf16 v130, v34, v99
  v_dot2c_f32_bf16 v131, v35, v99
  s_waitcnt vmcnt(18)
  v_dot2c_f32_bf16 v124, v34, v100
  v_dot2c_f32_bf16 v125, v35, v100
  v_dot2c_f32_bf16 v126, v34, v101
  v_dot2c_f32_bf16 v127, v35, v101
  v_dot2c_f32_bf16 v128, v34, v102
  v_dot2c_f32_bf16 v129, v35, v102
  v_dot2c_f32_bf16 v130, v34, v103
  v_dot2c_f32_bf16 v131, v35, v103
  s_waitcnt vmcnt(17)
  v_dot2c_f32_bf16 v124, v34, v104
  v_dot2c_f32_bf16 v125, v35, v104
  v_dot2c_f32_bf16 v126, v34, v105
  v_dot2c_f32_bf16 v127, v35, v105
  v_dot2c_f32_bf16 v128, v34, v106
  v_dot2c_f32_bf16 v129, v35, v106
  v_dot2c_f32_bf16 v130, v34, v107
  v_dot2c_f32_bf16 v131, v35, v107
  s_waitcnt vmcnt(16)
  v_dot2c_f32_bf16 v124, v34, v108
  v_dot2c_f32_bf16 v125, v35, v108
  v_dot2c_f32_bf16 v126, v34, v109
  v_dot2c_f32_bf16 v127, v35, v109
  v_dot2c_f32_bf16 v128, v34, v110
  v_dot2c_f32_bf16 v129, v35, v110
  v_dot2c_f32_bf16 v130, v34, v111
  v_dot2c_f32_bf16 v131, v35, v111
  s_waitcnt vmcnt(14)
  v_dot2c_f32_bf16 v124, v34, v114
  v_dot2c_f32_bf16 v125, v35, v114
  v_dot2c_f32_bf16 v126, v34, v115
  v_dot2c_f32_bf16 v127, v35, v115
  v_dot2c_f32_bf16 v128, v34, v116
  v_dot2c_f32_bf16 v129, v35, v116
  v_dot2c_f32_bf16 v130, v34, v117
  v_dot2c_f32_bf16 v131, v35, v117
  s_nop 3
  s_waitcnt vmcnt(13)
  v_lshlrev_b32 v200, 16, v140
  v_and_b32 v201, 0xffff0000, v140
  v_lshlrev_b32 v202, 16, v141
  v_and_b32 v203, 0xffff0000, v141
  v_lshlrev_b32 v204, 16, v142
  v_and_b32 v205, 0xffff0000, v142
  v_lshlrev_b32 v206, 16, v143
  v_and_b32 v207, 0xffff0000, v143
  s_nop 1
  s_waitcnt vmcnt(12)
  v_dot2c_f32_bf16 v200, v34, v144
  v_dot2c_f32_bf16 v201, v35, v144
  v_dot2c_f32_bf16 v202, v34, v145
  v_dot2c_f32_bf16 v203, v35, v145
  v_dot2c_f32_bf16 v204, v34, v146
  v_dot2c_f32_bf16 v205, v35, v146
  v_dot2c_f32_bf16 v206, v34, v147
  v_dot2c_f32_bf16 v207, v35, v147
  s_waitcnt vmcnt(11)
  v_dot2c_f32_bf16 v200, v34, v148
  v_dot2c_f32_bf16 v201, v35, v148
  v_dot2c_f32_bf16 v202, v34, v149
  v_dot2c_f32_bf16 v203, v35, v149
  v_dot2c_f32_bf16 v204, v34, v150
  v_dot2c_f32_bf16 v205, v35, v150
  v_dot2c_f32_bf16 v206, v34, v151
  v_dot2c_f32_bf16 v207, v35, v151
  s_waitcnt vmcnt(10)
  v_dot2c_f32_bf16 v200, v34, v152
  v_dot2c_f32_bf16 v201, v35, v152
  v_dot2c_f32_bf16 v202, v34, v153
  v_dot2c_f32_bf16 v203, v35, v153
  v_dot2c_f32_bf16 v204, v34, v154
  v_dot2c_f32_bf16 v205, v35, v154
  v_dot2c_f32_bf16 v206, v34, v155
  v_dot2c_f32_bf16 v207, v35, v155
  s_waitcnt vmcnt(9)
  v_dot2c_f32_bf16 v200, v34, v156
  v_dot2c_f32_bf16 v201, v35, v156
  v_dot2c_f32_bf16 v202, v34, v157
  v_dot2c_f32_bf16 v203, v35, v157
  v_dot2c_f32_bf16 v204, v34, v158
  v_dot2c_f32_bf16 v205, v35, v158
  v_dot2c_f32_bf16 v206, v34, v159
  v_dot2c_f32_bf16 v207, v35, v159
  s_waitcnt vmcnt(8)
  v_dot2c_f32_bf16 v200, v34, v160
  v_dot2c_f32_bf16 v201, v35, v160
  v_dot2c_f32_bf16 v202, v34, v161
  v_dot2c_f32_bf16 v203, v35, v161
  v_dot2c_f32_bf16 v204, v34, v162
  v_dot2c_f32_bf16 v205, v35, v162
  v_dot2c_f32_bf16 v206, v34, v163
  v_dot2c_f32_bf16 v207, v35, v163
  s_waitcnt vmcnt(7)
  v_dot2c_f32_bf16 v200, v34, v164
  v_dot2c_f32_bf16 v201, v35, v164
  v_dot2c_f32_bf16 v202, v34, v165
  v_dot2c_f32_bf16 v203, v35, v165
  v_dot2c_f32_bf16 v204, v34, v166
  v_dot2c_f32_bf16 v205, v35, v166
  v_dot2c_f32_bf16 v206, v34, v167
  v_dot2c_f32_bf16 v207, v35, v167
  s_waitcnt vmcnt(6)
  v_dot2c_f32_bf16 v200, v34, v168
  v_dot2c_f32_bf16 v201, v35, v168
  v_dot2c_f32_bf16 v202, v34, v169
  v_dot2c_f32_bf16 v203, v35, v169
  v_dot2c_f32_bf16 v204, v34, v170
  v_dot2c_f32_bf16 v205, v35, v170
  v_dot2c_f32_bf16 v206, v34, v171
  v_dot2c_f32_bf16 v207, v35, v171
  s_waitcnt vmcnt(5)
  v_dot2c_f32_bf16 v200, v34, v172
  v_dot2c_f32_bf16 v201, v35, v172
  v_dot2c_f32_bf16 v202, v34, v173
  v_dot2c_f32_bf16 v203, v35, v173
  v_dot2c_f32_bf16 v204, v34, v174
  v_dot2c_f32_bf16 v205, v35, v174
  v_dot2c_f32_bf16 v206, v34, v175
  v_dot2c_f32_bf16 v207, v35, v175
  s_waitcnt vmcnt(4)
  v_dot2c_f32_bf16 v200, v34, v176
  v_dot2c_f32_bf16 v201, v35, v176
  v_dot2c_f32_bf16 v202, v34, v177
  v_dot2c_f32_bf16 v203, v35, v177
  v_dot2c_f32_bf16 v204, v34, v178
  v_dot2c_f32_bf16 v205, v35, v178
  v_dot2c_f32_bf16 v206, v34, v179
  v_dot2c_f32_bf16 v207, v35, v179
  s_waitcnt vmcnt(3)
  v_dot2c_f32_bf16 v200, v34, v180
  v_dot2c_f32_bf16 v201, v35, v180
  v_dot2c_f32_bf16 v202, v34, v181
  v_dot2c_f32_bf16 v203, v35, v181
  v_dot2c_f32_bf16 v204, v34, v182
  v_dot2c_f32_bf16 v205, v35, v182
  v_dot2c_f32_bf16 v206, v34, v183
  v_dot2c_f32_bf16 v207, v35, v183
  s_waitcnt vmcnt(2)
  v_dot2c_f32_bf16 v200, v34, v184
  v_dot2c_f32_bf16 v201, v35, v184
  v_dot2c_f32_bf16 v202, v34, v185
  v_dot2c_f32_bf16 v203, v35, v185
  v_dot2c_f32_bf16 v204, v34, v186
  v_dot2c_f32_bf16 v205, v35, v186
  v_dot2c_f32_bf16 v206, v34, v187
  v_dot2c_f32_bf16 v207, v35, v187
  s_waitcnt vmcnt(0)
  v_dot2c_f32_bf16 v200, v34, v190
  v_dot2c_f32_bf16 v201, v35, v190
  v_dot2c_f32_bf16 v202, v34, v191
  v_dot2c_f32_bf16 v203, v35, v191
  v_dot2c_f32_bf16 v204, v34, v192
  v_dot2c_f32_bf16 v205, v35, v192
  v_dot2c_f32_bf16 v206, v34, v193
  v_dot2c_f32_bf16 v207, v35, v193
  s_nop 3
  s_cmp_eq_u32 s30, 0
  s_cbranch_scc0 L_f2a_done
  v_min_u32 v56, 3, v1
  v_add_u32 v56, 12, v56
  v_lshlrev_b32 v56, 2, v56
L_f2a_wait:
  buffer_load_dword v57, v56, s[12:15], s53 offen sc0 sc1
  s_waitcnt vmcnt(0)
  v_cmp_ne_u32 vcc, s52, v57
  s_nop 4
  s_cmp_eq_u64 vcc, 0
  s_cbranch_scc1 L_f2a_ok
  s_sleep 1
  s_branch L_f2a_wait
L_f2a_ok:
L_f2a_done:
  s_barrier
  s_add_u32 s57, s70, 24576
  buffer_load_dwordx4 v[64:67], v15, s[12:15], s57 offen sc0 sc1
  s_add_u32 s57, s57, 2048
  buffer_load_dwordx4 v[68:71], v15, s[12:15], s57 offen sc0 sc1
  s_add_u32 s57, s57, 2048
  buffer_load_dwordx4 v[72:75], v15, s[12:15], s57 offen sc0 sc1
  s_add_u32 s57, s57, 2048
  buffer_load_dwordx4 v[76:79], v15, s[12:15], s57 offen sc0 sc1
  s_mov_b32 s58, 38043648
  buffer_load_dword v120, v119, s[12:15], s58 offen sc0 sc1
  s_add_u32 s57, s74, 24576
  buffer_load_dwordx4 v[140:143], v15, s[12:15], s57 offen sc0 sc1
  s_add_u32 s57, s57, 2048
  buffer_load_dwordx4 v[144:147], v15, s[12:15], s57 offen sc0 sc1
  s_add_u32 s57, s57, 2048
  buffer_load_dwordx4 v[148:151], v15, s[12:15], s57 offen sc0 sc1
  s_add_u32 s57, s57, 2048
  buffer_load_dwordx4 v[152:155], v15, s[12:15], s57 offen sc0 sc1
  s_mov_b32 s58, 38043648
  buffer_load_dword v196, v195, s[12:15], s58 offen sc0 sc1
  s_waitcnt vmcnt(9)
  v_lshlrev_b32 v80, 16, v64
  v_and_b32 v81, 0xffff0000, v64
  v_lshlrev_b32 v82, 16, v65
  v_and_b32 v83, 0xffff0000, v65
  v_lshlrev_b32 v84, 16, v66
  v_and_b32 v85, 0xffff0000, v66
  v_lshlrev_b32 v86, 16, v67
  v_and_b32 v87, 0xffff0000, v67
  s_nop 1
  s_waitcnt vmcnt(8)
  v_dot2c_f32_bf16 v80, v34, v68
  v_dot2c_f32_bf16 v81, v35, v68
  v_dot2c_f32_bf16 v82, v34, v69
  v_dot2c_f32_bf16 v83, v35, v69
  v_dot2c_f32_bf16 v84, v34, v70
  v_dot2c_f32_bf16 v85, v35, v70
  v_dot2c_f32_bf16 v86, v34, v71
  v_dot2c_f32_bf16 v87, v35, v71
  s_waitcnt vmcnt(7)
  v_dot2c_f32_bf16 v80, v34, v72
  v_dot2c_f32_bf16 v81, v35, v72
  v_dot2c_f32_bf16 v82, v34, v73
  v_dot2c_f32_bf16 v83, v35, v73
  v_dot2c_f32_bf16 v84, v34, v74
  v_dot2c_f32_bf16 v85, v35, v74
  v_dot2c_f32_bf16 v86, v34, v75
  v_dot2c_f32_bf16 v87, v35, v75
  s_waitcnt vmcnt(6)
  v_dot2c_f32_bf16 v80, v34, v76
  v_dot2c_f32_bf16 v81, v35, v76
  v_dot2c_f32_bf16 v82, v34, v77
  v_dot2c_f32_bf16 v83, v35, v77
  v_dot2c_f32_bf16 v84, v34, v78
  v_dot2c_f32_bf16 v85, v35, v78
  v_dot2c_f32_bf16 v86, v34, v79
  v_dot2c_f32_bf16 v87, v35, v79
  s_nop 3
  s_waitcnt vmcnt(5)
  v_sub_f32 v80, v80, v124
  v_fma_f32 v124, v120, v80, v124
  v_sub_f32 v81, v81, v125
  v_fma_f32 v125, v120, v81, v125
  v_sub_f32 v82, v82, v126
  v_fma_f32 v126, v120, v82, v126
  v_sub_f32 v83, v83, v127
  v_fma_f32 v127, v120, v83, v127
  v_sub_f32 v84, v84, v128
  v_fma_f32 v128, v120, v84, v128
  v_sub_f32 v85, v85, v129
  v_fma_f32 v129, v120, v85, v129
  v_sub_f32 v86, v86, v130
  v_fma_f32 v130, v120, v86, v130
  v_sub_f32 v87, v87, v131
  v_fma_f32 v131, v120, v87, v131
  v_cvt_pk_bf16_f32 v36, v124, v125
  v_cvt_pk_bf16_f32 v37, v126, v127
  v_cvt_pk_bf16_f32 v38, v128, v129
  v_cvt_pk_bf16_f32 v39, v130, v131
  s_nop 1
  v_permlane32_swap_b32 v36, v38
  v_permlane32_swap_b32 v37, v39
  s_nop 1
  buffer_store_dwordx4 v[36:39], v121, s[4:7], 0 offen
  s_waitcnt vmcnt(5)
  v_lshlrev_b32 v156, 16, v140
  v_and_b32 v157, 0xffff0000, v140
  v_lshlrev_b32 v158, 16, v141
  v_and_b32 v159, 0xffff0000, v141
  v_lshlrev_b32 v160, 16, v142
  v_and_b32 v161, 0xffff0000, v142
  v_lshlrev_b32 v162, 16, v143
  v_and_b32 v163, 0xffff0000, v143
  s_nop 1
  s_waitcnt vmcnt(4)
  v_dot2c_f32_bf16 v156, v34, v144
  v_dot2c_f32_bf16 v157, v35, v144
  v_dot2c_f32_bf16 v158, v34, v145
  v_dot2c_f32_bf16 v159, v35, v145
  v_dot2c_f32_bf16 v160, v34, v146
  v_dot2c_f32_bf16 v161, v35, v146
  v_dot2c_f32_bf16 v162, v34, v147
  v_dot2c_f32_bf16 v163, v35, v147
  s_waitcnt vmcnt(3)
  v_dot2c_f32_bf16 v156, v34, v148
  v_dot2c_f32_bf16 v157, v35, v148
  v_dot2c_f32_bf16 v158, v34, v149
  v_dot2c_f32_bf16 v159, v35, v149
  v_dot2c_f32_bf16 v160, v34, v150
  v_dot2c_f32_bf16 v161, v35, v150
  v_dot2c_f32_bf16 v162, v34, v151
  v_dot2c_f32_bf16 v163, v35, v151
  s_waitcnt vmcnt(2)
  v_dot2c_f32_bf16 v156, v34, v152
  v_dot2c_f32_bf16 v157, v35, v152
  v_dot2c_f32_bf16 v158, v34, v153
  v_dot2c_f32_bf16 v159, v35, v153
  v_dot2c_f32_bf16 v160, v34, v154
  v_dot2c_f32_bf16 v161, v35, v154
  v_dot2c_f32_bf16 v162, v34, v155
  v_dot2c_f32_bf16 v163, v35, v155
  s_nop 3
  s_waitcnt vmcnt(1)
  v_sub_f32 v156, v156, v200
  v_fma_f32 v200, v196, v156, v200
  v_sub_f32 v157, v157, v201
  v_fma_f32 v201, v196, v157, v201
  v_sub_f32 v158, v158, v202
  v_fma_f32 v202, v196, v158, v202
  v_sub_f32 v159, v159, v203
  v_fma_f32 v203, v196, v159, v203
  v_sub_f32 v160, v160, v204
  v_fma_f32 v204, v196, v160, v204
  v_sub_f32 v161, v161, v205
  v_fma_f32 v205, v196, v161, v205
  v_sub_f32 v162, v162, v206
  v_fma_f32 v206, v196, v162, v206
  v_sub_f32 v163, v163, v207
  v_fma_f32 v207, v196, v163, v207
  v_cvt_pk_bf16_f32 v36, v200, v201
  v_cvt_pk_bf16_f32 v37, v202, v203
  v_cvt_pk_bf16_f32 v38, v204, v205
  v_cvt_pk_bf16_f32 v39, v206, v207
  s_nop 1
  v_permlane32_swap_b32 v36, v38
  v_permlane32_swap_b32 v37, v39
  s_nop 1
  buffer_store_dwordx4 v[36:39], v197, s[4:7], 0 offen
  s_branch L_f_end
L_f_one:
  s_waitcnt vmcnt(13)
  v_lshlrev_b32 v124, 16, v64
  v_and_b32 v125, 0xffff0000, v64
  v_lshlrev_b32 v126, 16, v65
  v_and_b32 v127, 0xffff0000, v65
  v_lshlrev_b32 v128, 16, v66
  v_and_b32 v129, 0xffff0000, v66
  v_lshlrev_b32 v130, 16, v67
  v_and_b32 v131, 0xffff0000, v67
  s_nop 1
  s_waitcnt vmcnt(12)
  v_dot2c_f32_bf16 v124, v34, v68
  v_dot2c_f32_bf16 v125, v35, v68
  v_dot2c_f32_bf16 v126, v34, v69
  v_dot2c_f32_bf16 v127, v35, v69
  v_dot2c_f32_bf16 v128, v34, v70
  v_dot2c_f32_bf16 v129, v35, v70
  v_dot2c_f32_bf16 v130, v34, v71
  v_dot2c_f32_bf16 v131, v35, v71
  s_waitcnt vmcnt(11)
  v_dot2c_f32_bf16 v124, v34, v72
  v_dot2c_f32_bf16 v125, v35, v72
  v_dot2c_f32_bf16 v126, v34, v73
  v_dot2c_f32_bf16 v127, v35, v73
  v_dot2c_f32_bf16 v128, v34, v74
  v_dot2c_f32_bf16 v129, v35, v74
  v_dot2c_f32_bf16 v130, v34, v75
  v_dot2c_f32_bf16 v131, v35, v75
  s_waitcnt vmcnt(10)
  v_dot2c_f32_bf16 v124, v34, v76
  v_dot2c_f32_bf16 v125, v35, v76
  v_dot2c_f32_bf16 v126, v34, v77
  v_dot2c_f32_bf16 v127, v35, v77
  v_dot2c_f32_bf16 v128, v34, v78
  v_dot2c_f32_bf16 v129, v35, v78
  v_dot2c_f32_bf16 v130, v34, v79
  v_dot2c_f32_bf16 v131, v35, v79
  s_waitcnt vmcnt(9)
  v_dot2c_f32_bf16 v124, v34, v80
  v_dot2c_f32_bf16 v125, v35, v80
  v_dot2c_f32_bf16 v126, v34, v81
  v_dot2c_f32_bf16 v127, v35, v81
  v_dot2c_f32_bf16 v128, v34, v82
  v_dot2c_f32_bf16 v129, v35, v82
  v_dot2c_f32_bf16 v130, v34, v83
  v_dot2c_f32_bf16 v131, v35, v83
  s_waitcnt vmcnt(8)
  v_dot2c_f32_bf16 v124, v34, v84
  v_dot2c_f32_bf16 v125, v35, v84
  v_dot2c_f32_bf16 v126, v34, v85
  v_dot2c_f32_bf16 v127, v35, v85
  v_dot2c_f32_bf16 v128, v34, v86
  v_dot2c_f32_bf16 v129, v35, v86
  v_dot2c_f32_bf16 v130, v34, v87
  v_dot2c_f32_bf16 v131, v35, v87
  s_waitcnt vmcnt(7)
  v_dot2c_f32_bf16 v124, v34, v88
  v_dot2c_f32_bf16 v125, v35, v88
  v_dot2c_f32_bf16 v126, v34, v89
  v_dot2c_f32_bf16 v127, v35, v89
  v_dot2c_f32_bf16 v128, v34, v90
  v_dot2c_f32_bf16 v129, v35, v90
  v_dot2c_f32_bf16 v130, v34, v91
  v_dot2c_f32_bf16 v131, v35, v91
  s_waitcnt vmcnt(6)
  v_dot2c_f32_bf16 v124, v34, v92
  v_dot2c_f32_bf16 v125, v35, v92
  v_dot2c_f32_bf16 v126, v34, v93
  v_dot2c_f32_bf16 v127, v35, v93
  v_dot2c_f32_bf16 v128, v34, v94
  v_dot2c_f32_bf16 v129, v35, v94
  v_dot2c_f32_bf16 v130, v34, v95
  v_dot2c_f32_bf16 v131, v35, v95
  s_waitcnt vmcnt(5)
  v_dot2c_f32_bf16 v124, v34, v96
  v_dot2c_f32_bf16 v125, v35, v96
  v_dot2c_f32_bf16 v126, v34, v97
  v_dot2c_f32_bf16 v127, v35, v97
  v_dot2c_f32_bf16 v128, v34, v98
  v_dot2c_f32_bf16 v129, v35, v98
  v_dot2c_f32_bf16 v130, v34, v99
  v_dot2c_f32_bf16 v131, v35, v99
  s_waitcnt vmcnt(4)
  v_dot2c_f32_bf16 v124, v34, v100
  v_dot2c_f32_bf16 v125, v35, v100
  v_dot2c_f32_bf16 v126, v34, v101
  v_dot2c_f32_bf16 v127, v35, v101
  v_dot2c_f32_bf16 v128, v34, v102
  v_dot2c_f32_bf16 v129, v35, v102
  v_dot2c_f32_bf16 v130, v34, v103
  v_dot2c_f32_bf16 v131, v35, v103
  s_waitcnt vmcnt(3)
  v_dot2c_f32_bf16 v124, v34, v104
  v_dot2c_f32_bf16 v125, v35, v104
  v_dot2c_f32_bf16 v126, v34, v105
  v_dot2c_f32_bf16 v127, v35, v105
  v_dot2c_f32_bf16 v128, v34, v106
  v_dot2c_f32_bf16 v129, v35, v106
  v_dot2c_f32_bf16 v130, v34, v107
  v_dot2c_f32_bf16 v131, v35, v107
  s_waitcnt vmcnt(2)
  v_dot2c_f32_bf16 v124, v34, v108
  v_dot2c_f32_bf16 v125, v35, v108
  v_dot2c_f32_bf16 v126, v34, v109
  v_dot2c_f32_bf16 v127, v35, v109
  v_dot2c_f32_bf16 v128, v34, v110
  v_dot2c_f32_bf16 v129, v35, v110
  v_dot2c_f32_bf16 v130, v34, v111
  v_dot2c_f32_bf16 v131, v35, v111
  s_waitcnt vmcnt(0)
  v_dot2c_f32_bf16 v124, v34, v114
  v_dot2c_f32_bf16 v125, v35, v114
  v_dot2c_f32_bf16 v126, v34, v115
  v_dot2c_f32_bf16 v127, v35, v115
  v_dot2c_f32_bf16 v128, v34, v116
  v_dot2c_f32_bf16 v129, v35, v116
  v_dot2c_f32_bf16 v130, v34, v117
  v_dot2c_f32_bf16 v131, v35, v117
  s_nop 3
  s_cmp_eq_u32 s30, 0
  s_cbranch_scc0 L_f2b_done
  v_min_u32 v56, 3, v1
  v_add_u32 v56, 12, v56
  v_lshlrev_b32 v56, 2, v56
L_f2b_wait:
  buffer_load_dword v57, v56, s[12:15], s53 offen sc0 sc1
  s_waitcnt vmcnt(0)
  v_cmp_ne_u32 vcc, s52, v57
  s_nop 4
  s_cmp_eq_u64 vcc, 0
  s_cbranch_scc1 L_f2b_ok
  s_sleep 1
  s_branch L_f2b_wait
L_f2b_ok:
L_f2b_done:
  s_barrier
  s_add_u32 s57, s70, 24576
  buffer_load_dwordx4 v[64:67], v15, s[12:15], s57 offen sc0 sc1
  s_add_u32 s57, s57, 2048
  buffer_load_dwordx4 v[68:71], v15, s[12:15], s57 offen sc0 sc1
  s_add_u32 s57, s57, 2048
  buffer_load_dwordx4 v[72:75], v15, s[12:15], s57 offen sc0 sc1
  s_add_u32 s57, s57, 2048
  buffer_load_dwordx4 v[76:79], v15, s[12:15], s57 offen sc0 sc1
  s_mov_b32 s58, 38043648
  buffer_load_dword v120, v119, s[12:15], s58 offen sc0 sc1
  s_waitcnt vmcnt(4)
  v_lshlrev_b32 v80, 16, v64
  v_and_b32 v81, 0xffff0000, v64
  v_lshlrev_b32 v82, 16, v65
  v_and_b32 v83, 0xffff0000, v65
  v_lshlrev_b32 v84, 16, v66
  v_and_b32 v85, 0xffff0000, v66
  v_lshlrev_b32 v86, 16, v67
  v_and_b32 v87, 0xffff0000, v67
  s_nop 1
  s_waitcnt vmcnt(3)
  v_dot2c_f32_bf16 v80, v34, v68
  v_dot2c_f32_bf16 v81, v35, v68
  v_dot2c_f32_bf16 v82, v34, v69
  v_dot2c_f32_bf16 v83, v35, v69
  v_dot2c_f32_bf16 v84, v34, v70
  v_dot2c_f32_bf16 v85, v35, v70
  v_dot2c_f32_bf16 v86, v34, v71
  v_dot2c_f32_bf16 v87, v35, v71
  s_waitcnt vmcnt(2)
  v_dot2c_f32_bf16 v80, v34, v72
  v_dot2c_f32_bf16 v81, v35, v72
  v_dot2c_f32_bf16 v82, v34, v73
  v_dot2c_f32_bf16 v83, v35, v73
  v_dot2c_f32_bf16 v84, v34, v74
  v_dot2c_f32_bf16 v85, v35, v74
  v_dot2c_f32_bf16 v86, v34, v75
  v_dot2c_f32_bf16 v87, v35, v75
  s_waitcnt vmcnt(1)
  v_dot2c_f32_bf16 v80, v34, v76
  v_dot2c_f32_bf16 v81, v35, v76
  v_dot2c_f32_bf16 v82, v34, v77
  v_dot2c_f32_bf16 v83, v35, v77
  v_dot2c_f32_bf16 v84, v34, v78
  v_dot2c_f32_bf16 v85, v35, v78
  v_dot2c_f32_bf16 v86, v34, v79
  v_dot2c_f32_bf16 v87, v35, v79
  s_nop 3
  s_waitcnt vmcnt(0)
  v_sub_f32 v80, v80, v124
  v_fma_f32 v124, v120, v80, v124
  v_sub_f32 v81, v81, v125
  v_fma_f32 v125, v120, v81, v125
  v_sub_f32 v82, v82, v126
  v_fma_f32 v126, v120, v82, v126
  v_sub_f32 v83, v83, v127
  v_fma_f32 v127, v120, v83, v127
  v_sub_f32 v84, v84, v128
  v_fma_f32 v128, v120, v84, v128
  v_sub_f32 v85, v85, v129
  v_fma_f32 v129, v120, v85, v129
  v_sub_f32 v86, v86, v130
  v_fma_f32 v130, v120, v86, v130
  v_sub_f32 v87, v87, v131
  v_fma_f32 v131, v120, v87, v131
  v_cvt_pk_bf16_f32 v36, v124, v125
  v_cvt_pk_bf16_f32 v37, v126, v127
  v_cvt_pk_bf16_f32 v38, v128, v129
  v_cvt_pk_bf16_f32 v39, v130, v131
  s_nop 1
  v_permlane32_swap_b32 v36, v38
  v_permlane32_swap_b32 v37, v39
  s_nop 1
  buffer_store_dwordx4 v[36:39], v121, s[4:7], 0 offen
L_f_end:
  s_waitcnt vmcnt(0)
  s_branch L_end1
L_attn:
  s_load_dwordx2 s[4:5], s[0:1], 0
  s_load_dwordx2 s[8:9], s[0:1], 8
  s_load_dwordx2 s[24:25], s[0:1], 16
  s_load_dwordx2 s[58:59], s[0:1], 64
  s_sub_u32 s43, s43, 24
  s_lshr_b32 s29, s42, 1
  s_and_b32 s28, s42, 1
  s_lshl_b32 s28, s28, 3
  s_add_u32 s28, s28, s43
  s_cmp_ge_u32 s28, 9
  s_cselect_b32 s44, 9, 0
  s_sub_u32 s49, s28, s44
  s_waitcnt lgkmcnt(0)
  s_mov_b32 s6, 2359296
  s_mov_b32 s7, 0x00020000
  s_mov_b32 s10, 1990656
  s_mov_b32 s11, 0x00020000
  s_mov_b32 s14, 268435456
  s_mov_b32 s15, 0x00020000
  s_mov_b32 s18, 256
  s_mov_b32 s19, 0x00020000
  s_mov_b32 s82, 0x3fb8aa3b
  s_mov_b32 s83, 0x358637bd
  v_and_b32 v1, 63, v0
  v_lshrrev_b32 v56, 6, v0
  s_nop 0
  v_readfirstlane_b32 s30, v56
  v_lshrrev_b32 v16, 3, v1
  v_and_b32 v18, 7, v1
  s_lshl_b32 s42, s30, 3
  v_add_u32 v16, s42, v16
  v_lshrrev_b32 v17, 1, v16
  v_and_b32 v17, 7, v17
  v_xor_b32 v17, v17, v18
  v_lshlrev_b32 v17, 4, v17
  v_mul_u32_u24 v99, 1152, v16
  v_add_u32 v99, v99, v17
  s_mul_i32 s47, s28, 147456
  s_lshl_b32 s48, s30, 10
  s_add_u32 m0, s48, 65536
  s_add_u32 s42, s47, 0
  buffer_load_dwordx4 v99, s[4:7], s42 offen lds
  s_add_u32 m0, s48, 73728
  s_add_u32 s42, s47, 73728
  buffer_load_dwordx4 v99, s[4:7], s42 offen lds
  v_lshrrev_b32 v17, 4, v1
  v_and_b32 v17, 1, v17
  v_lshlrev_b32 v17, 2, v17
  v_xor_b32 v97, v17, v18
  v_mul_u32_u24 v96, 3456, v16
  v_lshlrev_b32 v17, 4, v97
  v_mul_u32_u24 v3, 1152, v16
  v_add_u32 v3, v3, v17
  s_mul_i32 s55, s29, 144
  s_mul_i32 s54, s28, 52
  s_lshr_b32 s54, s54, 8
  s_mul_i32 s54, s54, 5
  s_sub_u32 s54, s28, s54
  s_mov_b32 s40, s54
  s_mov_b32 s34, 0
  s_lshl_b32 s42, s40, 6
  v_lshlrev_b32 v56, 3, v97
  v_add_u32 v56, s42, v56
  v_mov_b32 v57, 576
  v_mov_b32 v58, 1008
  v_cmp_le_u32 vcc, 144, v56
  v_mov_b32 v59, -288
  s_nop 0
  v_cndmask_b32 v57, v57, v58, vcc
  v_cmp_le_u32 vcc, 288, v56
  v_add_u32 v56, s55, v56
  s_nop 0
  v_cndmask_b32 v57, v57, v59, vcc
  v_add_u32 v56, v56, v57
  v_lshlrev_b32 v56, 1, v56
  v_add_u32 v2, v96, v56
  s_mov_b32 s36, s48
  s_mov_b32 s39, 221184
  s_mov_b32 s38, 0
  s_and_b32 m0, s36, 65535
  s_add_u32 s36, s36, 8192
  buffer_load_dwordx4 v2, s[8:11], s38 offen lds
  s_add_u32 s38, s38, s39
  s_add_u32 m0, s48, 81920
  s_add_u32 s42, s47, 128
  buffer_load_dwordx4 v99, s[4:7], s42 offen lds
  s_add_u32 m0, s48, 90112
  s_add_u32 s42, s47, 73856
  buffer_load_dwordx4 v99, s[4:7], s42 offen lds
  s_and_b32 m0, s36, 65535
  s_add_u32 s36, s36, 8192
  buffer_load_dwordx4 v2, s[8:11], s38 offen lds
  s_add_u32 s38, s38, s39
  s_cmp_eq_u32 s28, 0
  s_cbranch_scc0 L_nozero
  v_mov_b32 v24, 0
  v_mov_b32 v25, 0
  v_mov_b32 v26, 0
  v_mov_b32 v27, 0
  v_lshlrev_b32 v56, 4, v0
  s_mul_i32 s42, s29, 11520
  s_add_u32 s42, s42, 38051840
  buffer_store_dwordx4 v[24:27], v56, s[12:15], s42 offen sc0 sc1
  v_add_u32 v56, 8192, v56
  v_cmp_gt_u32 vcc, 11520, v56
  v_mov_b32 v57, 1073741824
  s_nop 0
  v_cndmask_b32 v56, v57, v56, vcc
  buffer_store_dwordx4 v[24:27], v56, s[12:15], s42 offen sc0 sc1
  s_waitcnt vmcnt(0)
  s_barrier
  s_cmp_eq_u32 s30, 0
  s_cbranch_scc0 L_nozero
  v_mov_b32 v56, 1
  s_lshl_b32 s42, s29, 2
  s_add_u32 s42, s42, 64
  v_mov_b32 v57, s42
  s_mov_b64 exec, 1
  buffer_atomic_add v56, v57, s[16:19], 0 offen sc1
  s_mov_b64 exec, -1
L_nozero:
  s_add_u32 m0, s48, 98304
  s_add_u32 s42, s47, 256
  buffer_load_dwordx4 v99, s[4:7], s42 offen lds
  s_add_u32 m0, s48, 106496
  s_add_u32 s42, s47, 73984
  buffer_load_dwordx4 v99, s[4:7], s42 offen lds
  s_and_b32 m0, s36, 65535
  s_add_u32 s36, s36, 8192
  buffer_load_dwordx4 v2, s[8:11], s38 offen lds
  s_add_u32 s38, s38, s39
  s_add_u32 m0, s48, 114688
  s_add_u32 s42, s47, 384
  buffer_load_dwordx4 v99, s[4:7], s42 offen lds
  s_add_u32 m0, s48, 122880
  s_add_u32 s42, s47, 74112
  buffer_load_dwordx4 v99, s[4:7], s42 offen lds
  s_and_b32 m0, s36, 65535
  s_add_u32 s36, s36, 8192
  buffer_load_dwordx4 v2, s[8:11], s38 offen lds
  s_add_u32 s38, s38, s39
  s_add_u32 m0, s48, 131072
  s_add_u32 s42, s47, 512
  buffer_load_dwordx4 v99, s[4:7], s42 offen lds
  s_add_u32 m0, s48, 139264
  s_add_u32 s42, s47, 74240
  buffer_load_dwordx4 v99, s[4:7], s42 offen lds
  s_and_b32 m0, s36, 65535
  s_add_u32 s36, s36, 8192
  buffer_load_dwordx4 v2, s[8:11], s38 offen lds
  s_add_u32 s38, s38, s39
  s_add_u32 m0, s48, 147456
  s_add_u32 s42, s47, 640
  buffer_load_dwordx4 v99, s[4:7], s42 offen lds
  s_add_u32 m0, s48, 155648
  s_add_u32 s42, s47, 74368
  buffer_load_dwordx4 v99, s[4:7], s42 offen lds
  s_and_b32 m0, s36, 65535
  s_add_u32 s36, s36, 8192
  buffer_load_dwordx4 v2, s[8:11], s38 offen lds
  s_add_u32 s38, s38, s39
  s_and_b32 s31, s30, 3
  s_lshr_b32 s32, s30, 2
  v_and_b32 v16, 15, v1
  v_lshrrev_b32 v16, 2, v16
  v_lshrrev_b32 v17, 1, v16
  v_xor_b32 v17, s32, v17
  v_lshlrev_b32 v17, 6, v17
  v_lshlrev_b32 v16, 7, v16
  v_add_u32 v16, v16, v17
  v_lshrrev_b32 v17, 4, v1
  v_and_b32 v17, 1, v17
  v_lshlrev_b32 v17, 5, v17
  v_add_u32 v16, v16, v17
  v_and_b32 v17, 3, v1
  v_lshlrev_b32 v17, 3, v17
  v_add_u32 v16, v16, v17
  v_lshrrev_b32 v17, 5, v1
  v_lshlrev_b32 v18, 10, v17
  v_add_u32 v5, v16, v18
  v_mov_b32 v6, v5
  v_and_b32 v16, 31, v1
  v_lshlrev_b32 v9, 4, v16
  s_lshl_b32 s42, s31, 5
  v_add_u32 v16, s42, v16
  v_lshrrev_b32 v18, 1, v16
  v_and_b32 v18, 7, v18
  v_xor_b32 v18, v18, v17
  v_lshlrev_b32 v18, 4, v18
  v_lshlrev_b32 v16, 7, v16
  v_add_u32 v14, v16, v18
  v_add_u32 v14, 65536, v14
  v_lshlrev_b32 v15, 4, v1
  v_and_b32 v16, 31, v1
  v_mul_u32_u24 v8, 272, v16
  v_lshlrev_b32 v17, 3, v17
  v_add_u32 v8, v8, v17
  s_lshl_b32 s42, s31, 6
  s_add_u32 s42, s42, 65536
  v_add_u32 v8, s42, v8
  s_waitcnt vmcnt(15)
  s_barrier
  v_xor_b32 v60, 0, v14
  ds_read_b128 v[112:115], v60 offset:0
  v_xor_b32 v61, 32, v14
  ds_read_b128 v[116:119], v61 offset:0
  v_xor_b32 v60, 64, v14
  ds_read_b128 v[120:123], v60 offset:0
  v_xor_b32 v61, 96, v14
  ds_read_b128 v[124:127], v61 offset:0
  ds_read_b64_tr_b16 v[32:33], v6 offset:0
  ds_read_b64_tr_b16 v[34:35], v6 offset:512
  ds_read_b64_tr_b16 v[36:37], v6 offset:2048
  ds_read_b64_tr_b16 v[38:39], v6 offset:2560
  ds_read_b64_tr_b16 v[40:41], v6 offset:4096
  ds_read_b64_tr_b16 v[42:43], v6 offset:4608
  ds_read_b64_tr_b16 v[44:45], v6 offset:6144
  ds_read_b64_tr_b16 v[46:47], v6 offset:6656
  v_add_u16 v6, 8192, v6
  s_waitcnt vmcnt(12) lgkmcnt(4)
  s_barrier
  v_mfma_f32_32x32x16_bf16 v[64:79], v[112:115], v[32:35], 0
  ds_read_b64_tr_b16 v[48:49], v6 offset:0
  ds_read_b64_tr_b16 v[50:51], v6 offset:512
  s_and_b32 m0, s36, 65535
  s_add_u32 s36, s36, 8192
  buffer_load_dwordx4 v2, s[8:11], s38 offen lds
  s_add_u32 s38, s38, s39
  v_xor_b32 v60, 0, v14
  ds_read_b128 v[128:131], v60 offset:16384
  v_xor_b32 v61, 32, v14
  ds_read_b128 v[132:135], v61 offset:16384
  v_xor_b32 v60, 64, v14
  ds_read_b128 v[136:139], v60 offset:16384
  v_xor_b32 v61, 96, v14
  ds_read_b128 v[140:143], v61 offset:16384
  v_mfma_f32_32x32x16_bf16 v[64:79], v[116:119], v[36:39], v[64:79]
  ds_read_b64_tr_b16 v[52:53], v6 offset:2048
  ds_read_b64_tr_b16 v[54:55], v6 offset:2560
  s_waitcnt lgkmcnt(8)
  v_mfma_f32_32x32x16_bf16 v[64:79], v[120:123], v[40:43], v[64:79]
  ds_read_b64_tr_b16 v[32:33], v6 offset:4096
  ds_read_b64_tr_b16 v[34:35], v6 offset:4608
  s_add_u32 m0, s48, 65536
  s_add_u32 s42, s47, 768
  buffer_load_dwordx4 v99, s[4:7], s42 offen lds
  s_add_u32 m0, s48, 73728
  s_add_u32 s42, s47, 74496
  buffer_load_dwordx4 v99, s[4:7], s42 offen lds
  ds_read_b64_tr_b16 v[36:37], v6 offset:6144
  ds_read_b64_tr_b16 v[38:39], v6 offset:6656
  v_add_u16 v6, 8192, v6
  v_mfma_f32_32x32x16_bf16 v[64:79], v[124:127], v[44:47], v[64:79]
  s_waitcnt vmcnt(12) lgkmcnt(4)
  s_barrier
  v_mfma_f32_32x32x16_bf16 v[64:79], v[128:131], v[48:51], v[64:79]
  ds_read_b64_tr_b16 v[40:41], v6 offset:0
  ds_read_b64_tr_b16 v[42:43], v6 offset:512
  s_and_b32 m0, s36, 65535
  s_add_u32 s36, s36, 8192
  buffer_load_dwordx4 v2, s[8:11], s38 offen lds
  s_add_u32 s38, s38, s39
  v_xor_b32 v60, 0, v14
  ds_read_b128 v[144:147], v60 offset:32768
  v_xor_b32 v61, 32, v14
  ds_read_b128 v[148:151], v61 offset:32768
  v_xor_b32 v60, 64, v14
  ds_read_b128 v[152:155], v60 offset:32768
  v_xor_b32 v61, 96, v14
  ds_read_b128 v[156:159], v61 offset:32768
  v_mfma_f32_32x32x16_bf16 v[64:79], v[132:135], v[52:55], v[64:79]
  ds_read_b64_tr_b16 v[44:45], v6 offset:2048
  ds_read_b64_tr_b16 v[46:47], v6 offset:2560
  s_waitcnt lgkmcnt(8)
  v_mfma_f32_32x32x16_bf16 v[64:79], v[136:139], v[32:35], v[64:79]
  ds_read_b64_tr_b16 v[48:49], v6 offset:4096
  ds_read_b64_tr_b16 v[50:51], v6 offset:4608
  s_add_u32 m0, s48, 81920
  s_add_u32 s42, s47, 896
  buffer_load_dwordx4 v99, s[4:7], s42 offen lds
  s_add_u32 m0, s48, 90112
  s_add_u32 s42, s47, 74624
  buffer_load_dwordx4 v99, s[4:7], s42 offen lds
  ds_read_b64_tr_b16 v[52:53], v6 offset:6144
  ds_read_b64_tr_b16 v[54:55], v6 offset:6656
  v_add_u16 v6, 8192, v6
  v_mfma_f32_32x32x16_bf16 v[64:79], v[140:143], v[36:39], v[64:79]
  s_waitcnt vmcnt(12) lgkmcnt(4)
  s_barrier
  v_mfma_f32_32x32x16_bf16 v[64:79], v[144:147], v[40:43], v[64:79]
  ds_read_b64_tr_b16 v[32:33], v6 offset:0
  ds_read_b64_tr_b16 v[34:35], v6 offset:512
  s_and_b32 m0, s36, 65535
  s_add_u32 s36, s36, 8192
  buffer_load_dwordx4 v2, s[8:11], s38 offen lds
  s_add_u32 s38, s38, s39
  v_xor_b32 v60, 0, v14
  ds_read_b128 v[160:163], v60 offset:49152
  v_xor_b32 v61, 32, v14
  ds_read_b128 v[164:167], v61 offset:49152
  v_xor_b32 v60, 64, v14
  ds_read_b128 v[168:171], v60 offset:49152
  v_xor_b32 v61, 96, v14
  ds_read_b128 v[172:175], v61 offset:49152
  v_mfma_f32_32x32x16_bf16 v[64:79], v[148:151], v[44:47], v[64:79]
  ds_read_b64_tr_b16 v[36:37], v6 offset:2048
  ds_read_b64_tr_b16 v[38:39], v6 offset:2560
  s_add_u32 s43, s34, 1
  s_min_u32 s43, s43, 6
  s_add_u32 s44, s43, s54
  s_cmp_ge_u32 s44, 5
  s_cselect_b32 s41, 5, 0
  s_sub_u32 s41, s44, s41
  s_add_u32 s44, s44, 1
  s_and_b32 s44, s44, 1
  s_add_u32 s44, s44, 5
  s_cmp_ge_u32 s43, 5
  s_cselect_b32 s41, s44, s41
  s_lshl_b32 s42, s41, 6
  v_lshlrev_b32 v56, 3, v97
  v_add_u32 v56, s42, v56
  v_mov_b32 v57, 576
  v_mov_b32 v58, 1008
  v_cmp_le_u32 vcc, 144, v56
  v_mov_b32 v59, -288
  s_nop 0
  v_cndmask_b32 v57, v57, v58, vcc
  v_cmp_le_u32 vcc, 288, v56
  v_add_u32 v56, s55, v56
  s_nop 0
  v_cndmask_b32 v57, v57, v59, vcc
  v_add_u32 v56, v56, v57
  v_lshlrev_b32 v56, 1, v56
  v_add_u32 v2, v96, v56
  s_cmp_eq_u32 s34, 6
  s_cselect_b32 s38, 1073741824, 0
  s_waitcnt lgkmcnt(8)
  v_mfma_f32_32x32x16_bf16 v[64:79], v[152:155], v[48:51], v[64:79]
  ds_read_b64_tr_b16 v[40:41], v6 offset:4096
  ds_read_b64_tr_b16 v[42:43], v6 offset:4608
  s_add_u32 m0, s48, 98304
  s_add_u32 s42, s47, 1024
  buffer_load_dwordx4 v99, s[4:7], s42 offen lds
  s_add_u32 m0, s48, 106496
  s_add_u32 s42, s47, 74752
  buffer_load_dwordx4 v99, s[4:7], s42 offen lds
  ds_read_b64_tr_b16 v[44:45], v6 offset:6144
  ds_read_b64_tr_b16 v[46:47], v6 offset:6656
  v_add_u16 v6, 8192, v6
  v_mfma_f32_32x32x16_bf16 v[64:79], v[156:159], v[52:55], v[64:79]
  s_waitcnt vmcnt(12) lgkmcnt(4)
  s_barrier
  v_mfma_f32_32x32x16_bf16 v[64:79], v[160:163], v[32:35], v[64:79]
  ds_read_b64_tr_b16 v[48:49], v6 offset:0
  ds_read_b64_tr_b16 v[50:51], v6 offset:512
  s_and_b32 m0, s36, 65535
  s_add_u32 s36, s36, 8192
  buffer_load_dwordx4 v2, s[8:11], s38 offen lds
  s_add_u32 s38, s38, s39
  v_xor_b32 v60, 0, v14
  v_add_u32 v60, 65536, v60
  ds_read_b128 v[176:179], v60
  v_xor_b32 v61, 32, v14
  v_add_u32 v61, 65536, v61
  ds_read_b128 v[180:183], v61
  v_xor_b32 v60, 64, v14
  v_add_u32 v60, 65536, v60
  ds_read_b128 v[184:187], v60
  v_xor_b32 v61, 96, v14
  v_add_u32 v61, 65536, v61
  ds_read_b128 v[188:191], v61
  v_mfma_f32_32x32x16_bf16 v[64:79], v[164:167], v[36:39], v[64:79]
  ds_read_b64_tr_b16 v[52:53], v6 offset:2048
  ds_read_b64_tr_b16 v[54:55], v6 offset:2560
  s_waitcnt lgkmcnt(8)
  v_mfma_f32_32x32x16_bf16 v[64:79], v[168:171], v[40:43], v[64:79]
  ds_read_b64_tr_b16 v[32:33], v6 offset:4096
  ds_read_b64_tr_b16 v[34:35], v6 offset:4608
  ds_read_b64_tr_b16 v[36:37], v6 offset:6144
  ds_read_b64_tr_b16 v[38:39], v6 offset:6656
  v_add_u16 v6, 8192, v6
  v_mfma_f32_32x32x16_bf16 v[64:79], v[172:175], v[44:47], v[64:79]
  s_waitcnt vmcnt(10) lgkmcnt(4)
  s_barrier
  v_mfma_f32_32x32x16_bf16 v[64:79], v[176:179], v[48:51], v[64:79]
  ds_read_b64_tr_b16 v[40:41], v6 offset:0
  ds_read_b64_tr_b16 v[42:43], v6 offset:512
  s_and_b32 m0, s36, 65535
  s_add_u32 s36, s36, 8192
  buffer_load_dwordx4 v2, s[8:11], s38 offen lds
  s_add_u32 s38, s38, s39
  v_xor_b32 v60, 0, v14
  v_add_u32 v60, 81920, v60
  ds_read_b128 v[192:195], v60
  v_xor_b32 v61, 32, v14
  v_add_u32 v61, 81920, v61
  ds_read_b128 v[196:199], v61
  v_xor_b32 v60, 64, v14
  v_add_u32 v60, 81920, v60
  ds_read_b128 v[200:203], v60
  v_xor_b32 v61, 96, v14
  v_add_u32 v61, 81920, v61
  ds_read_b128 v[204:207], v61
  v_mfma_f32_32x32x16_bf16 v[64:79], v[180:183], v[52:55], v[64:79]
  ds_read_b64_tr_b16 v[44:45], v6 offset:2048
  ds_read_b64_tr_b16 v[46:47], v6 offset:2560
  s_waitcnt lgkmcnt(8)
  v_mfma_f32_32x32x16_bf16 v[64:79], v[184:187], v[32:35], v[64:79]
  ds_read_b64_tr_b16 v[48:49], v6 offset:4096
  ds_read_b64_tr_b16 v[50:51], v6 offset:4608
  ds_read_b64_tr_b16 v[52:53], v6 offset:6144
  ds_read_b64_tr_b16 v[54:55], v6 offset:6656
  v_add_u16 v6, 8192, v6
  v_mfma_f32_32x32x16_bf16 v[64:79], v[188:191], v[36:39], v[64:79]
  s_waitcnt vmcnt(8) lgkmcnt(4)
  s_barrier
  v_mfma_f32_32x32x16_bf16 v[64:79], v[192:195], v[40:43], v[64:79]
  ds_read_b64_tr_b16 v[32:33], v6 offset:0
  ds_read_b64_tr_b16 v[34:35], v6 offset:512
  s_and_b32 m0, s36, 65535
  s_add_u32 s36, s36, 8192
  buffer_load_dwordx4 v2, s[8:11], s38 offen lds
  s_add_u32 s38, s38, s39
  v_xor_b32 v60, 0, v14
  ds_read_b128 v[208:211], v60 offset:0
  v_xor_b32 v61, 32, v14
  ds_read_b128 v[212:215], v61 offset:0
  v_xor_b32 v60, 64, v14
  ds_read_b128 v[216:219], v60 offset:0
  v_xor_b32 v61, 96, v14
  ds_read_b128 v[220:223], v61 offset:0
  v_mfma_f32_32x32x16_bf16 v[64:79], v[196:199], v[44:47], v[64:79]
  ds_read_b64_tr_b16 v[36:37], v6 offset:2048
  ds_read_b64_tr_b16 v[38:39], v6 offset:2560
  s_waitcnt lgkmcnt(8)
  v_mfma_f32_32x32x16_bf16 v[64:79], v[200:203], v[48:51], v[64:79]
  ds_read_b64_tr_b16 v[40:41], v6 offset:4096
  ds_read_b64_tr_b16 v[42:43], v6 offset:4608
  ds_read_b64_tr_b16 v[44:45], v6 offset:6144
  ds_read_b64_tr_b16 v[46:47], v6 offset:6656
  v_add_u16 v6, 8192, v6
  v_mfma_f32_32x32x16_bf16 v[64:79], v[204:207], v[52:55], v[64:79]
  s_waitcnt vmcnt(6) lgkmcnt(4)
  s_barrier
  v_mfma_f32_32x32x16_bf16 v[64:79], v[208:211], v[32:35], v[64:79]
  ds_read_b64_tr_b16 v[48:49], v6 offset:0
  ds_read_b64_tr_b16 v[50:51], v6 offset:512
  s_and_b32 m0, s36, 65535
  s_add_u32 s36, s36, 8192
  buffer_load_dwordx4 v2, s[8:11], s38 offen lds
  s_add_u32 s38, s38, s39
  v_xor_b32 v60, 0, v14
  ds_read_b128 v[224:227], v60 offset:16384
  v_xor_b32 v61, 32, v14
  ds_read_b128 v[228:231], v61 offset:16384
  v_xor_b32 v60, 64, v14
  ds_read_b128 v[232:235], v60 offset:16384
  v_xor_b32 v61, 96, v14
  ds_read_b128 v[236:239], v61 offset:16384
  v_mfma_f32_32x32x16_bf16 v[64:79], v[212:215], v[36:39], v[64:79]
  ds_read_b64_tr_b16 v[52:53], v6 offset:2048
  ds_read_b64_tr_b16 v[54:55], v6 offset:2560
  s_waitcnt lgkmcnt(8)
  v_mfma_f32_32x32x16_bf16 v[64:79], v[216:219], v[40:43], v[64:79]
  ds_read_b64_tr_b16 v[32:33], v6 offset:4096
  ds_read_b64_tr_b16 v[34:35], v6 offset:4608
  ds_read_b64_tr_b16 v[36:37], v6 offset:6144
  ds_read_b64_tr_b16 v[38:39], v6 offset:6656
  v_add_u16 v6, 8192, v6
  v_mfma_f32_32x32x16_bf16 v[64:79], v[220:223], v[44:47], v[64:79]
  s_waitcnt vmcnt(4) lgkmcnt(4)
  s_barrier
  v_mfma_f32_32x32x16_bf16 v[64:79], v[224:227], v[48:51], v[64:79]
  ds_read_b64_tr_b16 v[40:41], v6 offset:0
  ds_read_b64_tr_b16 v[42:43], v6 offset:512
  s_and_b32 m0, s36, 65535
  s_add_u32 s36, s36, 8192
  buffer_load_dwordx4 v2, s[8:11], s38 offen lds
  s_add_u32 s38, s38, s39
  v_xor_b32 v60, 0, v14
  ds_read_b128 v[240:243], v60 offset:32768
  v_xor_b32 v61, 32, v14
  ds_read_b128 v[244:247], v61 offset:32768
  v_xor_b32 v60, 64, v14
  ds_read_b128 v[248:251], v60 offset:32768
  v_xor_b32 v61, 96, v14
  ds_read_b128 v[252:255], v61 offset:32768
  v_mfma_f32_32x32x16_bf16 v[64:79], v[228:231], v[52:55], v[64:79]
  ds_read_b64_tr_b16 v[44:45], v6 offset:2048
  ds_read_b64_tr_b16 v[46:47], v6 offset:2560
  s_waitcnt lgkmcnt(8)
  v_mfma_f32_32x32x16_bf16 v[64:79], v[232:235], v[32:35], v[64:79]
  ds_read_b64_tr_b16 v[48:49], v6 offset:4096
  ds_read_b64_tr_b16 v[50:51], v6 offset:4608
  ds_read_b64_tr_b16 v[52:53], v6 offset:6144
  ds_read_b64_tr_b16 v[54:55], v6 offset:6656
  v_add_u16 v6, 8192, v6
  v_mfma_f32_32x32x16_bf16 v[64:79], v[236:239], v[36:39], v[64:79]
  s_waitcnt vmcnt(4) lgkmcnt(4)
  s_barrier
  v_mfma_f32_32x32x16_bf16 v[64:79], v[240:243], v[40:43], v[64:79]
  ds_read_b64_tr_b16 v[32:33], v6 offset:0
  ds_read_b64_tr_b16 v[34:35], v6 offset:512
  s_and_b32 m0, s36, 65535
  s_add_u32 s36, s36, 8192
  buffer_load_dwordx4 v2, s[8:11], s38 offen lds
  s_add_u32 s38, s38, s39
  v_mfma_f32_32x32x16_bf16 v[64:79], v[244:247], v[44:47], v[64:79]
  ds_read_b64_tr_b16 v[36:37], v6 offset:2048
  ds_read_b64_tr_b16 v[38:39], v6 offset:2560
  s_waitcnt lgkmcnt(4)
  v_mfma_f32_32x32x16_bf16 v[64:79], v[248:251], v[48:51], v[64:79]
  ds_read_b64_tr_b16 v[40:41], v6 offset:4096
  ds_read_b64_tr_b16 v[42:43], v6 offset:4608
  ds_read_b64_tr_b16 v[44:45], v6 offset:6144
  ds_read_b64_tr_b16 v[46:47], v6 offset:6656
  v_add_u16 v6, 8192, v6
  v_mfma_f32_32x32x16_bf16 v[80:95], v[252:255], v[52:55], v[64:79]
  s_lshl_b32 s42, s40, 6
  s_lshl_b32 s43, s32, 5
  s_add_u32 s42, s42, s43
  v_lshrrev_b32 v56, 4, v9
  v_add_u32 v56, s42, v56
  v_mov_b32 v57, 288
  v_cmp_gt_u32 vcc, 144, v56
  v_cmp_ge_u32 s[56:57], v56, v57
  s_cmp_ge_u32 s42, 320
  s_cselect_b32 s43, 288, 0
  s_sub_u32 s42, s42, s43
  s_mul_i32 s50, s42, 272
  s_or_b64 s[56:57], s[56:57], vcc
  v_add_u32 v63, s50, v8
  v_cmp_le_u32 vcc, 432, v56
  v_add_u32 v57, 88944, v8
  s_nop 0
  v_cndmask_b32 v63, v63, v57, vcc
  s_mov_b32 s40, s41
  s_mov_b32 s34, 1
  .p2align 3
L_T:
  s_waitcnt vmcnt(3) lgkmcnt(4)
  s_barrier
  v_mfma_f32_32x32x16_bf16 v[64:79], v[112:115], v[32:35], 0
  ds_read_b64_tr_b16 v[48:49], v6 offset:0
  ds_read_b64_tr_b16 v[50:51], v6 offset:512
  s_and_b32 m0, s36, 65535
  s_add_u32 s36, s36, 8192
  buffer_load_dwordx4 v2, s[8:11], s38 offen lds
  s_add_u32 s38, s38, s39
  v_mfma_f32_32x32x16_bf16 v[64:79], v[116:119], v[36:39], v[64:79]
  ds_read_b64_tr_b16 v[52:53], v6 offset:2048
  ds_read_b64_tr_b16 v[54:55], v6 offset:2560
  s_waitcnt lgkmcnt(4)
  v_mfma_f32_32x32x16_bf16 v[64:79], v[120:123], v[40:43], v[64:79]
  ds_read_b64_tr_b16 v[32:33], v6 offset:4096
  ds_read_b64_tr_b16 v[34:35], v6 offset:4608
  v_mfma_f32_32x32x16_bf16 v[64:79], v[124:127], v[44:47], v[64:79]
  v_min_f32 v16, 0, v80
  v_min_f32 v17, 0, v81
  v_min_f32 v18, 0, v82
  v_min_f32 v19, 0, v83
  v_mul_f32 v16, s82, v16
  v_mul_f32 v17, s82, v17
  ds_read_b64_tr_b16 v[36:37], v6 offset:6144
  ds_read_b64_tr_b16 v[38:39], v6 offset:6656
  v_add_u16 v6, 8192, v6
  s_waitcnt lgkmcnt(4)
  v_mfma_f32_32x32x16_bf16 v[64:79], v[128:131], v[48:51], v[64:79]
  v_mul_f32 v18, s82, v18
  v_mul_f32 v19, s82, v19
  v_max_f32 v20, 0, v80
  v_max_f32 v21, 0, v81
  v_max_f32 v22, 0, v82
  ds_read_b64_tr_b16 v[40:41], v6 offset:0
  ds_read_b64_tr_b16 v[42:43], v6 offset:512
  s_and_b32 m0, s36, 65535
  s_add_u32 s36, s36, 8192
  buffer_load_dwordx4 v2, s[8:11], s38 offen lds
  s_add_u32 s38, s38, s39
  v_mfma_f32_32x32x16_bf16 v[64:79], v[132:135], v[52:55], v[64:79]
  v_max_f32 v23, 0, v83
  v_exp_f32 v16, v16
  v_exp_f32 v17, v17
  v_exp_f32 v18, v18
  ds_read_b64_tr_b16 v[44:45], v6 offset:2048
  ds_read_b64_tr_b16 v[46:47], v6 offset:2560
  s_waitcnt lgkmcnt(4)
  v_mfma_f32_32x32x16_bf16 v[64:79], v[136:139], v[32:35], v[64:79]
  v_exp_f32 v19, v19
  v_add_f32 v20, s83, v20
  v_add_f32 v21, s83, v21
  v_add_f32 v22, s83, v22
  ds_read_b64_tr_b16 v[48:49], v6 offset:4096
  ds_read_b64_tr_b16 v[50:51], v6 offset:4608
  ds_read_b64_tr_b16 v[52:53], v6 offset:6144
  ds_read_b64_tr_b16 v[54:55], v6 offset:6656
  v_add_u16 v6, 8192, v6
  v_mfma_f32_32x32x16_bf16 v[64:79], v[140:143], v[36:39], v[64:79]
  s_waitcnt vmcnt(3) lgkmcnt(4)
  s_barrier
  v_mfma_f32_32x32x16_bf16 v[64:79], v[144:147], v[40:43], v[64:79]
  v_add_f32 v23, s83, v23
  v_add_f32 v16, v16, v20
  v_add_f32 v17, v17, v21
  v_add_f32 v18, v18, v22
  v_add_f32 v19, v19, v23
  ds_read_b64_tr_b16 v[32:33], v6 offset:0
  ds_read_b64_tr_b16 v[34:35], v6 offset:512
  s_and_b32 m0, s36, 65535
  s_add_u32 s36, s36, 8192
  buffer_load_dwordx4 v2, s[8:11], s38 offen lds
  s_add_u32 s38, s38, s39
  s_add_u32 s43, s34, 1
  s_min_u32 s43, s43, 6
  s_add_u32 s44, s43, s54
  s_cmp_ge_u32 s44, 5
  s_cselect_b32 s41, 5, 0
  s_sub_u32 s41, s44, s41
  s_add_u32 s44, s44, 1
  s_and_b32 s44, s44, 1
  s_add_u32 s44, s44, 5
  s_cmp_ge_u32 s43, 5
  s_cselect_b32 s41, s44, s41
  v_mfma_f32_32x32x16_bf16 v[64:79], v[148:151], v[44:47], v[64:79]
  v_cndmask_b32 v16, v80, v16, s[56:57]
  v_cndmask_b32 v17, v81, v17, s[56:57]
  v_cndmask_b32 v18, v82, v18, s[56:57]
  v_cndmask_b32 v19, v83, v19, s[56:57]
  v_cvt_pk_bf16_f32 v24, v16, v17
  v_cvt_pk_bf16_f32 v25, v18, v19
  ds_read_b64_tr_b16 v[36:37], v6 offset:2048
  ds_read_b64_tr_b16 v[38:39], v6 offset:2560
  s_lshl_b32 s42, s41, 6
  v_lshlrev_b32 v56, 3, v97
  v_add_u32 v56, s42, v56
  v_mov_b32 v57, 576
  v_mov_b32 v58, 1008
  v_cmp_le_u32 vcc, 144, v56
  v_mov_b32 v59, -288
  s_nop 0
  v_cndmask_b32 v57, v57, v58, vcc
  s_waitcnt lgkmcnt(4)
  v_mfma_f32_32x32x16_bf16 v[64:79], v[152:155], v[48:51], v[64:79]
  v_min_f32 v16, 0, v84
  v_min_f32 v17, 0, v85
  v_min_f32 v18, 0, v86
  v_min_f32 v19, 0, v87
  v_mul_f32 v16, s82, v16
  v_mul_f32 v17, s82, v17
  ds_read_b64_tr_b16 v[40:41], v6 offset:4096
  ds_read_b64_tr_b16 v[42:43], v6 offset:4608
  v_cmp_le_u32 vcc, 288, v56
  v_add_u32 v56, s55, v56
  s_nop 0
  v_cndmask_b32 v57, v57, v59, vcc
  v_add_u32 v56, v56, v57
  v_lshlrev_b32 v56, 1, v56
  v_add_u32 v2, v96, v56
  s_cmp_eq_u32 s34, 6
  s_cselect_b32 s38, 1073741824, 0
  v_mfma_f32_32x32x16_bf16 v[64:79], v[156:159], v[52:55], v[64:79]
  v_mul_f32 v18, s82, v18
  v_mul_f32 v19, s82, v19
  v_max_f32 v20, 0, v84
  v_max_f32 v21, 0, v85
  v_max_f32 v22, 0, v86
  ds_read_b64_tr_b16 v[44:45], v6 offset:6144
  ds_read_b64_tr_b16 v[46:47], v6 offset:6656
  v_add_u16 v6, 8192, v6
  s_waitcnt lgkmcnt(4)
  v_mfma_f32_32x32x16_bf16 v[64:79], v[160:163], v[32:35], v[64:79]
  v_max_f32 v23, 0, v87
  v_exp_f32 v16, v16
  v_exp_f32 v17, v17
  v_exp_f32 v18, v18
  ds_read_b64_tr_b16 v[48:49], v6 offset:0
  ds_read_b64_tr_b16 v[50:51], v6 offset:512
  s_and_b32 m0, s36, 65535
  s_add_u32 s36, s36, 8192
  buffer_load_dwordx4 v2, s[8:11], s38 offen lds
  s_add_u32 s38, s38, s39
  v_mfma_f32_32x32x16_bf16 v[64:79], v[164:167], v[36:39], v[64:79]
  v_exp_f32 v19, v19
  v_add_f32 v20, s83, v20
  v_add_f32 v21, s83, v21
  v_add_f32 v22, s83, v22
  ds_read_b64_tr_b16 v[52:53], v6 offset:2048
  ds_read_b64_tr_b16 v[54:55], v6 offset:2560
  s_cmp_eq_u32 s34, 4
  s_cbranch_scc1 L_T_zl
L_T_zl_ret:
  s_waitcnt lgkmcnt(4)
  v_mfma_f32_32x32x16_bf16 v[64:79], v[168:171], v[40:43], v[64:79]
  v_add_f32 v23, s83, v23
  v_add_f32 v16, v16, v20
  v_add_f32 v17, v17, v21
  v_add_f32 v18, v18, v22
  v_add_f32 v19, v19, v23
  ds_read_b64_tr_b16 v[32:33], v6 offset:4096
  ds_read_b64_tr_b16 v[34:35], v6 offset:4608
  ds_read_b64_tr_b16 v[36:37], v6 offset:6144
  ds_read_b64_tr_b16 v[38:39], v6 offset:6656
  v_add_u16 v6, 8192, v6
  v_mfma_f32_32x32x16_bf16 v[64:79], v[172:175], v[44:47], v[64:79]
  s_waitcnt vmcnt(3) lgkmcnt(4)
  s_barrier
  v_mfma_f32_32x32x16_bf16 v[64:79], v[176:179], v[48:51], v[64:79]
  v_cndmask_b32 v16, v84, v16, s[56:57]
  v_cndmask_b32 v17, v85, v17, s[56:57]
  v_cndmask_b32 v18, v86, v18, s[56:57]
  v_cndmask_b32 v19, v87, v19, s[56:57]
  v_cvt_pk_bf16_f32 v26, v16, v17
  v_cvt_pk_bf16_f32 v27, v18, v19
  ds_read_b64_tr_b16 v[40:41], v6 offset:0
  ds_read_b64_tr_b16 v[42:43], v6 offset:512
  s_and_b32 m0, s36, 65535
  s_add_u32 s36, s36, 8192
  buffer_load_dwordx4 v2, s[8:11], s38 offen lds
  s_add_u32 s38, s38, s39
  s_cmp_eq_u32 s34, 5
  s_cbranch_scc1 L_T_kvs
L_T_kvs_ret:
  v_mfma_f32_32x32x16_bf16 v[64:79], v[180:183], v[52:55], v[64:79]
  v_min_f32 v16, 0, v88
  v_min_f32 v17, 0, v89
  v_min_f32 v18, 0, v90
  v_min_f32 v19, 0, v91
  v_mul_f32 v16, s82, v16
  v_mul_f32 v17, s82, v17
  ds_read_b64_tr_b16 v[44:45], v6 offset:2048
  ds_read_b64_tr_b16 v[46:47], v6 offset:2560
  s_waitcnt lgkmcnt(4)
  v_mfma_f32_32x32x16_bf16 v[64:79], v[184:187], v[32:35], v[64:79]
  v_mul_f32 v18, s82, v18
  v_mul_f32 v19, s82, v19
  v_max_f32 v20, 0, v88
  v_max_f32 v21, 0, v89
  v_max_f32 v22, 0, v90
  ds_read_b64_tr_b16 v[48:49], v6 offset:4096
  ds_read_b64_tr_b16 v[50:51], v6 offset:4608
  v_mfma_f32_32x32x16_bf16 v[64:79], v[188:191], v[36:39], v[64:79]
  v_max_f32 v23, 0, v91
  v_exp_f32 v16, v16
  v_exp_f32 v17, v17
  v_exp_f32 v18, v18
  ds_read_b64_tr_b16 v[52:53], v6 offset:6144
  ds_read_b64_tr_b16 v[54:55], v6 offset:6656
  v_add_u16 v6, 8192, v6
  s_waitcnt lgkmcnt(4)
  v_mfma_f32_32x32x16_bf16 v[64:79], v[192:195], v[40:43], v[64:79]
  v_exp_f32 v19, v19
  v_add_f32 v20, s83, v20
  v_add_f32 v21, s83, v21
  v_add_f32 v22, s83, v22
  ds_read_b64_tr_b16 v[32:33], v6 offset:0
  ds_read_b64_tr_b16 v[34:35], v6 offset:512
  s_and_b32 m0, s36, 65535
  s_add_u32 s36, s36, 8192
  buffer_load_dwordx4 v2, s[8:11], s38 offen lds
  s_add_u32 s38, s38, s39
  v_mfma_f32_32x32x16_bf16 v[64:79], v[196:199], v[44:47], v[64:79]
  v_add_f32 v23, s83, v23
  v_add_f32 v16, v16, v20
  v_add_f32 v17, v17, v21
  v_add_f32 v18, v18, v22
  v_add_f32 v19, v19, v23
  ds_read_b64_tr_b16 v[36:37], v6 offset:2048
  ds_read_b64_tr_b16 v[38:39], v6 offset:2560
  s_waitcnt lgkmcnt(4)
  v_mfma_f32_32x32x16_bf16 v[64:79], v[200:203], v[48:51], v[64:79]
  v_cndmask_b32 v16, v88, v16, s[56:57]
  v_cndmask_b32 v17, v89, v17, s[56:57]
  v_cndmask_b32 v18, v90, v18, s[56:57]
  v_cndmask_b32 v19, v91, v19, s[56:57]
  v_cvt_pk_bf16_f32 v28, v16, v17
  v_cvt_pk_bf16_f32 v29, v18, v19
  ds_read_b64_tr_b16 v[40:41], v6 offset:4096
  ds_read_b64_tr_b16 v[42:43], v6 offset:4608
  ds_read_b64_tr_b16 v[44:45], v6 offset:6144
  ds_read_b64_tr_b16 v[46:47], v6 offset:6656
  v_add_u16 v6, 8192, v6
  v_mfma_f32_32x32x16_bf16 v[64:79], v[204:207], v[52:55], v[64:79]
  s_waitcnt vmcnt(3) lgkmcnt(4)
  s_barrier
  v_mfma_f32_32x32x16_bf16 v[64:79], v[208:211], v[32:35], v[64:79]
  v_min_f32 v16, 0, v92
  v_min_f32 v17, 0, v93
  v_min_f32 v18, 0, v94
  v_min_f32 v19, 0, v95
  v_mul_f32 v16, s82, v16
  v_mul_f32 v17, s82, v17
  ds_read_b64_tr_b16 v[48:49], v6 offset:0
  ds_read_b64_tr_b16 v[50:51], v6 offset:512
  s_and_b32 m0, s36, 65535
  s_add_u32 s36, s36, 8192
  buffer_load_dwordx4 v2, s[8:11], s38 offen lds
  s_add_u32 s38, s38, s39
  v_mfma_f32_32x32x16_bf16 v[64:79], v[212:215], v[36:39], v[64:79]
  v_mul_f32 v18, s82, v18
  v_mul_f32 v19, s82, v19
  v_max_f32 v20, 0, v92
  v_max_f32 v21, 0, v93
  v_max_f32 v22, 0, v94
  ds_read_b64_tr_b16 v[52:53], v6 offset:2048
  ds_read_b64_tr_b16 v[54:55], v6 offset:2560
  s_waitcnt lgkmcnt(4)
  v_mfma_f32_32x32x16_bf16 v[64:79], v[216:219], v[40:43], v[64:79]
  v_max_f32 v23, 0, v95
  v_exp_f32 v16, v16
  v_exp_f32 v17, v17
  v_exp_f32 v18, v18
  ds_read_b64_tr_b16 v[32:33], v6 offset:4096
  ds_read_b64_tr_b16 v[34:35], v6 offset:4608
  v_mfma_f32_32x32x16_bf16 v[64:79], v[220:223], v[44:47], v[64:79]
  v_exp_f32 v19, v19
  v_add_f32 v20, s83, v20
  v_add_f32 v21, s83, v21
  v_add_f32 v22, s83, v22
  ds_read_b64_tr_b16 v[36:37], v6 offset:6144
  ds_read_b64_tr_b16 v[38:39], v6 offset:6656
  v_add_u16 v6, 8192, v6
  s_waitcnt lgkmcnt(4)
  v_mfma_f32_32x32x16_bf16 v[64:79], v[224:227], v[48:51], v[64:79]
  v_add_f32 v23, s83, v23
  v_add_f32 v16, v16, v20
  v_add_f32 v17, v17, v21
  v_add_f32 v18, v18, v22
  v_add_f32 v19, v19, v23
  ds_read_b64_tr_b16 v[40:41], v6 offset:0
  ds_read_b64_tr_b16 v[42:43], v6 offset:512
  s_and_b32 m0, s36, 65535
  s_add_u32 s36, s36, 8192
  buffer_load_dwordx4 v2, s[8:11], s38 offen lds
  s_add_u32 s38, s38, s39
  v_mfma_f32_32x32x16_bf16 v[64:79], v[228:231], v[52:55], v[64:79]
  v_cndmask_b32 v16, v92, v16, s[56:57]
  v_cndmask_b32 v17, v93, v17, s[56:57]
  v_cndmask_b32 v18, v94, v18, s[56:57]
  v_cndmask_b32 v19, v95, v19, s[56:57]
  v_cvt_pk_bf16_f32 v30, v16, v17
  v_cvt_pk_bf16_f32 v31, v18, v19
  ds_read_b64_tr_b16 v[44:45], v6 offset:2048
  ds_read_b64_tr_b16 v[46:47], v6 offset:2560
  s_waitcnt lgkmcnt(4)
  v_mfma_f32_32x32x16_bf16 v[64:79], v[232:235], v[32:35], v[64:79]
  ds_read_b64_tr_b16 v[48:49], v6 offset:4096
  ds_read_b64_tr_b16 v[50:51], v6 offset:4608
  v_mov_b32 v101, v63
  ds_read_b64_tr_b16 v[52:53], v6 offset:6144
  ds_read_b64_tr_b16 v[54:55], v6 offset:6656
  v_add_u16 v6, 8192, v6
  v_mfma_f32_32x32x16_bf16 v[64:79], v[236:239], v[36:39], v[64:79]
  s_waitcnt vmcnt(4) lgkmcnt(4)
  s_barrier
  v_mfma_f32_32x32x16_bf16 v[64:79], v[240:243], v[40:43], v[64:79]
  ds_read_b64_tr_b16 v[32:33], v6 offset:0
  ds_read_b64_tr_b16 v[34:35], v6 offset:512
  s_and_b32 m0, s36, 65535
  s_add_u32 s36, s36, 8192
  buffer_load_dwordx4 v2, s[8:11], s38 offen lds
  s_add_u32 s38, s38, s39
  s_lshl_b32 s42, s40, 6
  s_lshl_b32 s43, s32, 5
  s_add_u32 s42, s42, s43
  v_lshrrev_b32 v56, 4, v9
  v_add_u32 v56, s42, v56
  v_mov_b32 v57, 288
  v_cmp_gt_u32 vcc, 144, v56
  v_mfma_f32_32x32x16_bf16 v[64:79], v[244:247], v[44:47], v[64:79]
  ds_read_b64_tr_b16 v[36:37], v6 offset:2048
  ds_read_b64_tr_b16 v[38:39], v6 offset:2560
  v_cmp_ge_u32 s[56:57], v56, v57
  s_cmp_ge_u32 s42, 320
  s_cselect_b32 s43, 288, 0
  s_sub_u32 s42, s42, s43
  s_mul_i32 s50, s42, 272
  s_or_b64 s[56:57], s[56:57], vcc
  v_add_u32 v63, s50, v8
  v_cmp_le_u32 vcc, 432, v56
  v_add_u32 v57, 88944, v8
  s_nop 0
  v_cndmask_b32 v63, v63, v57, vcc
  s_waitcnt lgkmcnt(4)
  v_mfma_f32_32x32x16_bf16 v[64:79], v[248:251], v[48:51], v[64:79]
  ds_read_b64_tr_b16 v[40:41], v6 offset:4096
  ds_read_b64_tr_b16 v[42:43], v6 offset:4608
  ds_read_b64_tr_b16 v[44:45], v6 offset:6144
  ds_read_b64_tr_b16 v[46:47], v6 offset:6656
  v_add_u16 v6, 8192, v6
  v_mfma_f32_32x32x16_bf16 v[80:95], v[252:255], v[52:55], v[64:79]
  ds_write_b64 v101, v[24:25] offset:0
  ds_write_b64 v101, v[26:27] offset:16
  ds_write_b64 v101, v[28:29] offset:32
  ds_write_b64 v101, v[30:31] offset:48
  s_cmp_eq_u32 s34, 4
  s_cbranch_scc1 L_KV
L_KV_ret:
  s_mov_b32 s40, s41
  s_add_u32 s34, s34, 1
  s_cmp_le_u32 s34, 6
  s_cbranch_scc1 L_T
  s_branch L_T_done
L_T_kvs:
  s_cmp_eq_u32 s30, 0
  s_cbranch_scc0 L_T_kvs_ret
  v_mov_b32 v56, 1
  s_lshl_b32 s42, s29, 2
  s_add_u32 s42, s42, 80
  v_mov_b32 v57, s42
  s_mov_b64 exec, 1
  buffer_atomic_add v56, v57, s[16:19], 0 offen sc1
  s_mov_b64 exec, -1
  s_branch L_T_kvs_ret
L_T_zl:
  s_lshl_b32 s42, s29, 2
  s_add_u32 s42, s42, 64
  v_mov_b32 v58, s42
  buffer_load_dword v98, v58, s[16:19], 0 offen sc1
  s_branch L_T_zl_ret
L_KV:
  s_nop 11
  v_min_f32 v16, 0, v80
  v_min_f32 v17, 0, v81
  v_min_f32 v18, 0, v82
  v_min_f32 v19, 0, v83
  v_mul_f32 v16, s82, v16
  v_mul_f32 v17, s82, v17
  v_mul_f32 v18, s82, v18
  v_mul_f32 v19, s82, v19
  v_max_f32 v20, 0, v80
  v_max_f32 v21, 0, v81
  v_max_f32 v22, 0, v82
  v_max_f32 v23, 0, v83
  v_exp_f32 v16, v16
  v_exp_f32 v17, v17
  v_exp_f32 v18, v18
  v_exp_f32 v19, v19
  v_add_f32 v20, s83, v20
  v_add_f32 v21, s83, v21
  v_add_f32 v22, s83, v22
  v_add_f32 v23, s83, v23
  v_add_f32 v16, v16, v20
  v_add_f32 v17, v17, v21
  v_add_f32 v18, v18, v22
  v_add_f32 v19, v19, v23
  v_cndmask_b32 v16, v80, v16, s[56:57]
  v_cndmask_b32 v17, v81, v17, s[56:57]
  v_cndmask_b32 v18, v82, v18, s[56:57]
  v_cndmask_b32 v19, v83, v19, s[56:57]
  v_cvt_pk_bf16_f32 v24, v16, v17
  v_cvt_pk_bf16_f32 v25, v18, v19
  ds_write_b64 v63, v[24:25] offset:0
  v_min_f32 v16, 0, v84
  v_min_f32 v17, 0, v85
  v_min_f32 v18, 0, v86
  v_min_f32 v19, 0, v87
  v_mul_f32 v16, s82, v16
  v_mul_f32 v17, s82, v17
  v_mul_f32 v18, s82, v18
  v_mul_f32 v19, s82, v19
  v_max_f32 v20, 0, v84
  v_max_f32 v21, 0, v85
  v_max_f32 v22, 0, v86
  v_max_f32 v23, 0, v87
  v_exp_f32 v16, v16
  v_exp_f32 v17, v17
  v_exp_f32 v18, v18
  v_exp_f32 v19, v19
  v_add_f32 v20, s83, v20
  v_add_f32 v21, s83, v21
  v_add_f32 v22, s83, v22
  v_add_f32 v23, s83, v23
  v_add_f32 v16, v16, v20
  v_add_f32 v17, v17, v21
  v_add_f32 v18, v18, v22
  v_add_f32 v19, v19, v23
  v_cndmask_b32 v16, v84, v16, s[56:57]
  v_cndmask_b32 v17, v85, v17, s[56:57]
  v_cndmask_b32 v18, v86, v18, s[56:57]
  v_cndmask_b32 v19, v87, v19, s[56:57]
  v_cvt_pk_bf16_f32 v26, v16, v17
  v_cvt_pk_bf16_f32 v27, v18, v19
  ds_write_b64 v63, v[26:27] offset:16
  v_min_f32 v16, 0, v88
  v_min_f32 v17, 0, v89
  v_min_f32 v18, 0, v90
  v_min_f32 v19, 0, v91
  v_mul_f32 v16, s82, v16
  v_mul_f32 v17, s82, v17
  v_mul_f32 v18, s82, v18
  v_mul_f32 v19, s82, v19
  v_max_f32 v20, 0, v88
  v_max_f32 v21, 0, v89
  v_max_f32 v22, 0, v90
  v_max_f32 v23, 0, v91
  v_exp_f32 v16, v16
  v_exp_f32 v17, v17
  v_exp_f32 v18, v18
  v_exp_f32 v19, v19
  v_add_f32 v20, s83, v20
  v_add_f32 v21, s83, v21
  v_add_f32 v22, s83, v22
  v_add_f32 v23, s83, v23
  v_add_f32 v16, v16, v20
  v_add_f32 v17, v17, v21
  v_add_f32 v18, v18, v22
  v_add_f32 v19, v19, v23
  v_cndmask_b32 v16, v88, v16, s[56:57]
  v_cndmask_b32 v17, v89, v17, s[56:57]
  v_cndmask_b32 v18, v90, v18, s[56:57]
  v_cndmask_b32 v19, v91, v19, s[56:57]
  v_cvt_pk_bf16_f32 v28, v16, v17
  v_cvt_pk_bf16_f32 v29, v18, v19
  ds_write_b64 v63, v[28:29] offset:32
  v_min_f32 v16, 0, v92
  v_min_f32 v17, 0, v93
  v_min_f32 v18, 0, v94
  v_min_f32 v19, 0, v95
  v_mul_f32 v16, s82, v16
  v_mul_f32 v17, s82, v17
  v_mul_f32 v18, s82, v18
  v_mul_f32 v19, s82, v19
  v_max_f32 v20, 0, v92
  v_max_f32 v21, 0, v93
  v_max_f32 v22, 0, v94
  v_max_f32 v23, 0, v95
  v_exp_f32 v16, v16
  v_exp_f32 v17, v17
  v_exp_f32 v18, v18
  v_exp_f32 v19, v19
  v_add_f32 v20, s83, v20
  v_add_f32 v21, s83, v21
  v_add_f32 v22, s83, v22
  v_add_f32 v23, s83, v23
  v_add_f32 v16, v16, v20
  v_add_f32 v17, v17, v21
  v_add_f32 v18, v18, v22
  v_add_f32 v19, v19, v23
  v_cndmask_b32 v16, v92, v16, s[56:57]
  v_cndmask_b32 v17, v93, v17, s[56:57]
  v_cndmask_b32 v18, v94, v18, s[56:57]
  v_cndmask_b32 v19, v95, v19, s[56:57]
  v_cvt_pk_bf16_f32 v30, v16, v17
  v_cvt_pk_bf16_f32 v31, v18, v19
  ds_write_b64 v63, v[30:31] offset:48
  s_waitcnt lgkmcnt(0)
  s_barrier
  s_mul_i32 s42, s30, 4896
  s_add_u32 s42, s42, 65536
  v_lshrrev_b32 v56, 4, v9
  v_mul_u32_u24 v57, 272, v56
  v_lshrrev_b32 v58, 5, v1
  v_lshlrev_b32 v58, 4, v58
  v_add_u32 v57, v57, v58
  v_add_u32 v57, s42, v57
  v_add_u32 v58, 39168, v57
  v_cmp_eq_u32 vcc, 18, v56
  v_mov_b32 v59, 0x3f803f80
  ds_read_b128 v[16:19], v57 offset:0
  ds_read_b128 v[20:23], v58 offset:0
  ds_read_b128 v[24:27], v57 offset:32
  ds_read_b128 v[28:31], v58 offset:32
  s_waitcnt lgkmcnt(2)
  v_cndmask_b32 v20, v20, v59, vcc
  v_cndmask_b32 v21, v21, v59, vcc
  v_cndmask_b32 v22, v22, v59, vcc
  v_cndmask_b32 v23, v23, v59, vcc
  s_nop 1
  v_mfma_f32_32x32x16_bf16 v[64:79], v[16:19], v[20:23], 0
  s_nop 3
  ds_read_b128 v[16:19], v57 offset:64
  ds_read_b128 v[20:23], v58 offset:64
  s_waitcnt lgkmcnt(2)
  v_cndmask_b32 v28, v28, v59, vcc
  v_cndmask_b32 v29, v29, v59, vcc
  v_cndmask_b32 v30, v30, v59, vcc
  v_cndmask_b32 v31, v31, v59, vcc
  s_nop 1
  v_mfma_f32_32x32x16_bf16 v[64:79], v[24:27], v[28:31], v[64:79]
  s_nop 3
  ds_read_b128 v[24:27], v57 offset:96
  ds_read_b128 v[28:31], v58 offset:96
  s_waitcnt lgkmcnt(2)
  v_cndmask_b32 v20, v20, v59, vcc
  v_cndmask_b32 v21, v21, v59, vcc
  v_cndmask_b32 v22, v22, v59, vcc
  v_cndmask_b32 v23, v23, v59, vcc
  s_nop 1
  v_mfma_f32_32x32x16_bf16 v[64:79], v[16:19], v[20:23], v[64:79]
  s_nop 3
  ds_read_b128 v[16:19], v57 offset:128
  ds_read_b128 v[20:23], v58 offset:128
  s_waitcnt lgkmcnt(2)
  v_cndmask_b32 v28, v28, v59, vcc
  v_cndmask_b32 v29, v29, v59, vcc
  v_cndmask_b32 v30, v30, v59, vcc
  v_cndmask_b32 v31, v31, v59, vcc
  s_nop 1
  v_mfma_f32_32x32x16_bf16 v[64:79], v[24:27], v[28:31], v[64:79]
  s_nop 3
  ds_read_b128 v[24:27], v57 offset:160
  ds_read_b128 v[28:31], v58 offset:160
  s_waitcnt lgkmcnt(2)
  v_cndmask_b32 v20, v20, v59, vcc
  v_cndmask_b32 v21, v21, v59, vcc
  v_cndmask_b32 v22, v22, v59, vcc
  v_cndmask_b32 v23, v23, v59, vcc
  s_nop 1
  v_mfma_f32_32x32x16_bf16 v[64:79], v[16:19], v[20:23], v[64:79]
  s_nop 3
  ds_read_b128 v[16:19], v57 offset:192
  ds_read_b128 v[20:23], v58 offset:192
  s_waitcnt lgkmcnt(2)
  v_cndmask_b32 v28, v28, v59, vcc
  v_cndmask_b32 v29, v29, v59, vcc
  v_cndmask_b32 v30, v30, v59, vcc
  v_cndmask_b32 v31, v31, v59, vcc
  s_nop 1
  v_mfma_f32_32x32x16_bf16 v[64:79], v[24:27], v[28:31], v[64:79]
  s_nop 3
  ds_read_b128 v[24:27], v57 offset:224
  ds_read_b128 v[28:31], v58 offset:224
  s_waitcnt lgkmcnt(2)
  v_cndmask_b32 v20, v20, v59, vcc
  v_cndmask_b32 v21, v21, v59, vcc
  v_cndmask_b32 v22, v22, v59, vcc
  v_cndmask_b32 v23, v23, v59, vcc
  s_nop 1
  v_mfma_f32_32x32x16_bf16 v[64:79], v[16:19], v[20:23], v[64:79]
  s_nop 3
  s_waitcnt lgkmcnt(0)
  v_cndmask_b32 v28, v28, v59, vcc
  v_cndmask_b32 v29, v29, v59, vcc
  v_cndmask_b32 v30, v30, v59, vcc
  v_cndmask_b32 v31, v31, v59, vcc
  s_nop 1
  v_mfma_f32_32x32x16_bf16 v[64:79], v[24:27], v[28:31], v[64:79]
  s_nop 3
  s_waitcnt vmcnt(5)
  v_readfirstlane_b32 s42, v98
  s_nop 3
  s_cmp_ge_u32 s42, 1
  s_cbranch_scc1 L_zok
  s_lshl_b32 s42, s29, 2
  s_add_u32 s42, s42, 64
  v_mov_b32 v60, s42
L_zpoll:
  buffer_load_dword v61, v60, s[16:19], 0 offen sc1
  s_waitcnt vmcnt(0)
  v_readfirstlane_b32 s42, v61
  s_nop 3
  s_cmp_ge_u32 s42, 1
  s_cbranch_scc1 L_zok
  s_sleep 1
  s_branch L_zpoll
L_zok:
  s_lshl_b32 s42, s29, 3
  s_add_u32 s42, s42, s30
  s_mul_i32 s42, s42, 1440
  s_add_u32 s42, s42, 38051840
  v_lshrrev_b32 v58, 5, v1
  v_mul_u32_u24 v58, 320, v58
  v_lshlrev_b32 v59, 2, v56
  v_add_u32 v58, v58, v59
  v_cmp_gt_u32 vcc, 19, v56
  v_mov_b32 v59, 1073741824
  s_nop 0
  v_cndmask_b32 v58, v59, v58, vcc
  v_cmp_gt_u32 vcc, 32, v1
  s_nop 1
  v_cndmask_b32 v60, v59, v58, vcc
  s_nop 7
  buffer_atomic_add_f32 v64, v58, s[12:15], s42 offen offset:0
  buffer_atomic_add_f32 v65, v58, s[12:15], s42 offen offset:80
  buffer_atomic_add_f32 v66, v58, s[12:15], s42 offen offset:160
  buffer_atomic_add_f32 v67, v58, s[12:15], s42 offen offset:240
  buffer_atomic_add_f32 v68, v58, s[12:15], s42 offen offset:640
  buffer_atomic_add_f32 v69, v58, s[12:15], s42 offen offset:720
  buffer_atomic_add_f32 v70, v58, s[12:15], s42 offen offset:800
  buffer_atomic_add_f32 v71, v58, s[12:15], s42 offen offset:880
  buffer_atomic_add_f32 v72, v60, s[12:15], s42 offen offset:1280
  buffer_atomic_add_f32 v73, v60, s[12:15], s42 offen offset:1360
  s_barrier
  s_cmp_eq_u32 s32, 1
  s_cbranch_scc0 L_KV_nomv
  v_add_u32 v61, 78336, v8
  ds_read_b64 v[16:17], v61 offset:0
  ds_read_b64 v[18:19], v61 offset:16
  ds_read_b64 v[20:21], v61 offset:32
  ds_read_b64 v[22:23], v61 offset:48
  s_waitcnt lgkmcnt(0)
  ds_write_b64 v8, v[16:17] offset:0
  ds_write_b64 v8, v[18:19] offset:16
  ds_write_b64 v8, v[20:21] offset:32
  ds_write_b64 v8, v[22:23] offset:48
L_KV_nomv:
  v_add_u32 v63, 88944, v8
  s_load_dwordx2 s[52:53], s[0:1], 64
  s_waitcnt lgkmcnt(0)
  s_mov_b32 s20, s52
  s_mov_b32 s21, s53
  s_mov_b32 s22, 1152
  s_mov_b32 s23, 0x00020000
  s_cmp_lt_u32 s30, 2
  s_cbranch_scc0 L_nogw
  s_add_u32 m0, s48, 152576
  v_lshlrev_b32 v56, 4, v0
  buffer_load_dwordx4 v56, s[20:23], 0 offen lds
L_nogw:
  s_mov_b32 s40, s41
  s_add_u32 s34, s34, 1
  s_waitcnt vmcnt(3) lgkmcnt(4)
  s_barrier
  v_mfma_f32_32x32x16_bf16 v[64:79], v[112:115], v[32:35], 0
  ds_read_b64_tr_b16 v[48:49], v6 offset:0
  ds_read_b64_tr_b16 v[50:51], v6 offset:512
  s_and_b32 m0, s36, 65535
  s_add_u32 s36, s36, 8192
  buffer_load_dwordx4 v2, s[8:11], s38 offen lds
  s_add_u32 s38, s38, s39
  v_mfma_f32_32x32x16_bf16 v[64:79], v[116:119], v[36:39], v[64:79]
  ds_read_b64_tr_b16 v[52:53], v6 offset:2048
  ds_read_b64_tr_b16 v[54:55], v6 offset:2560
  s_waitcnt lgkmcnt(4)
  v_mfma_f32_32x32x16_bf16 v[64:79], v[120:123], v[40:43], v[64:79]
  ds_read_b64_tr_b16 v[32:33], v6 offset:4096
  ds_read_b64_tr_b16 v[34:35], v6 offset:4608
  v_mfma_f32_32x32x16_bf16 v[64:79], v[124:127], v[44:47], v[64:79]
  ds_read_b64_tr_b16 v[36:37], v6 offset:6144
  ds_read_b64_tr_b16 v[38:39], v6 offset:6656
  v_add_u16 v6, 8192, v6
  s_waitcnt lgkmcnt(4)
  v_mfma_f32_32x32x16_bf16 v[64:79], v[128:131], v[48:51], v[64:79]
  ds_read_b64_tr_b16 v[40:41], v6 offset:0
  ds_read_b64_tr_b16 v[42:43], v6 offset:512
  s_and_b32 m0, s36, 65535
  s_add_u32 s36, s36, 8192
  buffer_load_dwordx4 v2, s[8:11], s38 offen lds
  s_add_u32 s38, s38, s39
  v_mfma_f32_32x32x16_bf16 v[64:79], v[132:135], v[52:55], v[64:79]
  ds_read_b64_tr_b16 v[44:45], v6 offset:2048
  ds_read_b64_tr_b16 v[46:47], v6 offset:2560
  s_waitcnt lgkmcnt(4)
  v_mfma_f32_32x32x16_bf16 v[64:79], v[136:139], v[32:35], v[64:79]
  ds_read_b64_tr_b16 v[48:49], v6 offset:4096
  ds_read_b64_tr_b16 v[50:51], v6 offset:4608
  ds_read_b64_tr_b16 v[52:53], v6 offset:6144
  ds_read_b64_tr_b16 v[54:55], v6 offset:6656
  v_add_u16 v6, 8192, v6
  v_mfma_f32_32x32x16_bf16 v[64:79], v[140:143], v[36:39], v[64:79]
  s_waitcnt vmcnt(3) lgkmcnt(4)
  s_barrier
  v_mfma_f32_32x32x16_bf16 v[64:79], v[144:147], v[40:43], v[64:79]
  ds_read_b64_tr_b16 v[32:33], v6 offset:0
  ds_read_b64_tr_b16 v[34:35], v6 offset:512
  s_and_b32 m0, s36, 65535
  s_add_u32 s36, s36, 8192
  buffer_load_dwordx4 v2, s[8:11], s38 offen lds
  s_add_u32 s38, s38, s39
  s_add_u32 s43, s34, 1
  s_min_u32 s43, s43, 6
  s_add_u32 s44, s43, s54
  s_cmp_ge_u32 s44, 5
  s_cselect_b32 s41, 5, 0
  s_sub_u32 s41, s44, s41
  s_add_u32 s44, s44, 1
  s_and_b32 s44, s44, 1
  s_add_u32 s44, s44, 5
  s_cmp_ge_u32 s43, 5
  s_cselect_b32 s41, s44, s41
  v_mfma_f32_32x32x16_bf16 v[64:79], v[148:151], v[44:47], v[64:79]
  ds_read_b64_tr_b16 v[36:37], v6 offset:2048
  ds_read_b64_tr_b16 v[38:39], v6 offset:2560
  s_lshl_b32 s42, s41, 6
  v_lshlrev_b32 v56, 3, v97
  v_add_u32 v56, s42, v56
  v_mov_b32 v57, 576
  v_mov_b32 v58, 1008
  v_cmp_le_u32 vcc, 144, v56
  v_mov_b32 v59, -288
  s_nop 0
  v_cndmask_b32 v57, v57, v58, vcc
  s_waitcnt lgkmcnt(4)
  v_mfma_f32_32x32x16_bf16 v[64:79], v[152:155], v[48:51], v[64:79]
  ds_read_b64_tr_b16 v[40:41], v6 offset:4096
  ds_read_b64_tr_b16 v[42:43], v6 offset:4608
  v_cmp_le_u32 vcc, 288, v56
  v_add_u32 v56, s55, v56
  s_nop 0
  v_cndmask_b32 v57, v57, v59, vcc
  v_add_u32 v56, v56, v57
  v_lshlrev_b32 v56, 1, v56
  v_add_u32 v2, v96, v56
  s_cmp_eq_u32 s34, 6
  s_cselect_b32 s38, 1073741824, 0
  v_mfma_f32_32x32x16_bf16 v[64:79], v[156:159], v[52:55], v[64:79]
  ds_read_b64_tr_b16 v[44:45], v6 offset:6144
  ds_read_b64_tr_b16 v[46:47], v6 offset:6656
  v_add_u16 v6, 8192, v6
  s_waitcnt lgkmcnt(4)
  v_mfma_f32_32x32x16_bf16 v[64:79], v[160:163], v[32:35], v[64:79]
  ds_read_b64_tr_b16 v[48:49], v6 offset:0
  ds_read_b64_tr_b16 v[50:51], v6 offset:512
  s_and_b32 m0, s36, 65535
  s_add_u32 s36, s36, 8192
  buffer_load_dwordx4 v2, s[8:11], s38 offen lds
  s_add_u32 s38, s38, s39
  v_mfma_f32_32x32x16_bf16 v[64:79], v[164:167], v[36:39], v[64:79]
  ds_read_b64_tr_b16 v[52:53], v6 offset:2048
  ds_read_b64_tr_b16 v[54:55], v6 offset:2560
  s_waitcnt lgkmcnt(4)
  v_mfma_f32_32x32x16_bf16 v[64:79], v[168:171], v[40:43], v[64:79]
  ds_read_b64_tr_b16 v[32:33], v6 offset:4096
  ds_read_b64_tr_b16 v[34:35], v6 offset:4608
  ds_read_b64_tr_b16 v[36:37], v6 offset:6144
  ds_read_b64_tr_b16 v[38:39], v6 offset:6656
  v_add_u16 v6, 8192, v6
  v_mfma_f32_32x32x16_bf16 v[64:79], v[172:175], v[44:47], v[64:79]
  s_waitcnt vmcnt(3) lgkmcnt(4)
  s_barrier
  v_mfma_f32_32x32x16_bf16 v[64:79], v[176:179], v[48:51], v[64:79]
  ds_read_b64_tr_b16 v[40:41], v6 offset:0
  ds_read_b64_tr_b16 v[42:43], v6 offset:512
  s_and_b32 m0, s36, 65535
  s_add_u32 s36, s36, 8192
  buffer_load_dwordx4 v2, s[8:11], s38 offen lds
  s_add_u32 s38, s38, s39
  s_cmp_eq_u32 s30, 0
  s_cbranch_scc0 Lk5_21
  v_mov_b32 v56, 1
  s_lshl_b32 s42, s29, 2
  s_add_u32 s42, s42, 80
  v_mov_b32 v57, s42
  s_mov_b64 exec, 1
  buffer_atomic_add v56, v57, s[16:19], 0 offen sc1
  s_mov_b64 exec, -1
Lk5_21:
  v_mfma_f32_32x32x16_bf16 v[64:79], v[180:183], v[52:55], v[64:79]
  ds_read_b64_tr_b16 v[44:45], v6 offset:2048
  ds_read_b64_tr_b16 v[46:47], v6 offset:2560
  s_waitcnt lgkmcnt(4)
  v_mfma_f32_32x32x16_bf16 v[64:79], v[184:187], v[32:35], v[64:79]
  ds_read_b64_tr_b16 v[48:49], v6 offset:4096
  ds_read_b64_tr_b16 v[50:51], v6 offset:4608
  v_mfma_f32_32x32x16_bf16 v[64:79], v[188:191], v[36:39], v[64:79]
  ds_read_b64_tr_b16 v[52:53], v6 offset:6144
  ds_read_b64_tr_b16 v[54:55], v6 offset:6656
  v_add_u16 v6, 8192, v6
  s_waitcnt lgkmcnt(4)
  v_mfma_f32_32x32x16_bf16 v[64:79], v[192:195], v[40:43], v[64:79]
  ds_read_b64_tr_b16 v[32:33], v6 offset:0
  ds_read_b64_tr_b16 v[34:35], v6 offset:512
  s_and_b32 m0, s36, 65535
  s_add_u32 s36, s36, 8192
  buffer_load_dwordx4 v2, s[8:11], s38 offen lds
  s_add_u32 s38, s38, s39
  v_mfma_f32_32x32x16_bf16 v[64:79], v[196:199], v[44:47], v[64:79]
  ds_read_b64_tr_b16 v[36:37], v6 offset:2048
  ds_read_b64_tr_b16 v[38:39], v6 offset:2560
  s_waitcnt lgkmcnt(4)
  v_mfma_f32_32x32x16_bf16 v[64:79], v[200:203], v[48:51], v[64:79]
  ds_read_b64_tr_b16 v[40:41], v6 offset:4096
  ds_read_b64_tr_b16 v[42:43], v6 offset:4608
  ds_read_b64_tr_b16 v[44:45], v6 offset:6144
  ds_read_b64_tr_b16 v[46:47], v6 offset:6656
  v_add_u16 v6, 8192, v6
  v_mfma_f32_32x32x16_bf16 v[64:79], v[204:207], v[52:55], v[64:79]
  s_waitcnt vmcnt(3) lgkmcnt(4)
  s_barrier
  v_mfma_f32_32x32x16_bf16 v[64:79], v[208:211], v[32:35], v[64:79]
  ds_read_b64_tr_b16 v[48:49], v6 offset:0
  ds_read_b64_tr_b16 v[50:51], v6 offset:512
  s_and_b32 m0, s36, 65535
  s_add_u32 s36, s36, 8192
  buffer_load_dwordx4 v2, s[8:11], s38 offen lds
  s_add_u32 s38, s38, s39
  v_mfma_f32_32x32x16_bf16 v[64:79], v[212:215], v[36:39], v[64:79]
  ds_read_b64_tr_b16 v[52:53], v6 offset:2048
  ds_read_b64_tr_b16 v[54:55], v6 offset:2560
  s_waitcnt lgkmcnt(4)
  v_mfma_f32_32x32x16_bf16 v[64:79], v[216:219], v[40:43], v[64:79]
  ds_read_b64_tr_b16 v[32:33], v6 offset:4096
  ds_read_b64_tr_b16 v[34:35], v6 offset:4608
  v_mfma_f32_32x32x16_bf16 v[64:79], v[220:223], v[44:47], v[64:79]
  ds_read_b64_tr_b16 v[36:37], v6 offset:6144
  ds_read_b64_tr_b16 v[38:39], v6 offset:6656
  v_add_u16 v6, 8192, v6
  s_waitcnt lgkmcnt(4)
  v_mfma_f32_32x32x16_bf16 v[64:79], v[224:227], v[48:51], v[64:79]
  ds_read_b64_tr_b16 v[40:41], v6 offset:0
  ds_read_b64_tr_b16 v[42:43], v6 offset:512
  s_and_b32 m0, s36, 65535
  s_add_u32 s36, s36, 8192
  buffer_load_dwordx4 v2, s[8:11], s38 offen lds
  s_add_u32 s38, s38, s39
  v_mfma_f32_32x32x16_bf16 v[64:79], v[228:231], v[52:55], v[64:79]
  ds_read_b64_tr_b16 v[44:45], v6 offset:2048
  ds_read_b64_tr_b16 v[46:47], v6 offset:2560
  s_waitcnt lgkmcnt(4)
  v_mfma_f32_32x32x16_bf16 v[64:79], v[232:235], v[32:35], v[64:79]
  ds_read_b64_tr_b16 v[48:49], v6 offset:4096
  ds_read_b64_tr_b16 v[50:51], v6 offset:4608
  ds_read_b64_tr_b16 v[52:53], v6 offset:6144
  ds_read_b64_tr_b16 v[54:55], v6 offset:6656
  v_add_u16 v6, 8192, v6
  v_mfma_f32_32x32x16_bf16 v[64:79], v[236:239], v[36:39], v[64:79]
  s_waitcnt vmcnt(4) lgkmcnt(4)
  s_barrier
  v_mfma_f32_32x32x16_bf16 v[64:79], v[240:243], v[40:43], v[64:79]
  ds_read_b64_tr_b16 v[32:33], v6 offset:0
  ds_read_b64_tr_b16 v[34:35], v6 offset:512
  s_and_b32 m0, s36, 65535
  s_add_u32 s36, s36, 8192
  buffer_load_dwordx4 v2, s[8:11], s38 offen lds
  s_add_u32 s38, s38, s39
  s_lshl_b32 s42, s40, 6
  s_lshl_b32 s43, s32, 5
  s_add_u32 s42, s42, s43
  v_lshrrev_b32 v56, 4, v9
  v_add_u32 v56, s42, v56
  v_mov_b32 v57, 288
  v_cmp_gt_u32 vcc, 144, v56
  v_mfma_f32_32x32x16_bf16 v[64:79], v[244:247], v[44:47], v[64:79]
  ds_read_b64_tr_b16 v[36:37], v6 offset:2048
  ds_read_b64_tr_b16 v[38:39], v6 offset:2560
  v_cmp_ge_u32 s[56:57], v56, v57
  s_cmp_ge_u32 s42, 320
  s_cselect_b32 s43, 288, 0
  s_sub_u32 s42, s42, s43
  s_mul_i32 s50, s42, 272
  s_or_b64 s[56:57], s[56:57], vcc
  v_add_u32 v63, s50, v8
  v_cmp_le_u32 vcc, 432, v56
  v_add_u32 v57, 88944, v8
  s_nop 0
  v_cndmask_b32 v63, v63, v57, vcc
  s_waitcnt lgkmcnt(4)
  v_mfma_f32_32x32x16_bf16 v[64:79], v[248:251], v[48:51], v[64:79]
  ds_read_b64_tr_b16 v[40:41], v6 offset:4096
  ds_read_b64_tr_b16 v[42:43], v6 offset:4608
  ds_read_b64_tr_b16 v[44:45], v6 offset:6144
  ds_read_b64_tr_b16 v[46:47], v6 offset:6656
  v_add_u16 v6, 8192, v6
  v_mfma_f32_32x32x16_bf16 v[80:95], v[252:255], v[52:55], v[64:79]
  s_branch L_KV_ret
L_T_done:
  s_lshl_b32 s42, s29, 2
  s_add_u32 s42, s42, 80
  v_mov_b32 v60, s42
L_kvpoll:
  buffer_load_dword v61, v60, s[16:19], 0 offen sc1
  s_waitcnt vmcnt(0)
  v_readfirstlane_b32 s42, v61
  s_nop 3
  s_cmp_ge_u32 s42, 16
  s_cbranch_scc1 L_kvnopoll
  s_sleep 2
  s_branch L_kvpoll
L_kvnopoll:
  s_mul_i32 s42, s29, 11520
  s_add_u32 s42, s42, 38051840
  v_lshlrev_b32 v56, 4, v0
  buffer_load_dwordx4 v[64:67], v56, s[12:15], s42 offen sc0 sc1
  v_add_u32 v57, 8192, v56
  v_cmp_gt_u32 vcc, 11520, v57
  v_mov_b32 v58, 1073741824
  s_nop 0
  v_cndmask_b32 v57, v58, v57, vcc
  buffer_load_dwordx4 v[68:71], v57, s[12:15], s42 offen sc0 sc1
  s_waitcnt lgkmcnt(0)
  s_barrier
  s_mov_b32 s8, s24
  s_mov_b32 s9, s25
  s_mov_b32 s10, 663552
  s_mul_i32 s33, s29, 165888
  s_add_u32 s42, s49, 0
  s_cmp_ge_u32 s42, 9
  s_cselect_b32 s43, 9, 0
  s_sub_u32 s42, s42, s43
  s_lshl_b32 s42, s42, 7
  s_add_u32 s38, s33, s42
  s_add_u32 m0, s48, 0
  s_add_u32 s42, s38, 0
  buffer_load_dwordx4 v3, s[8:11], s42 offen lds
  s_add_u32 m0, s48, 8192
  s_add_u32 s42, s38, 73728
  buffer_load_dwordx4 v3, s[8:11], s42 offen lds
  s_cmp_lt_u32 s30, 2
  s_cbranch_scc0 Lw3_22
  s_add_u32 m0, s48, 16384
  s_add_u32 s42, s38, 147456
  buffer_load_dwordx4 v3, s[8:11], s42 offen lds
Lw3_22:
  s_add_u32 s42, s49, 1
  s_cmp_ge_u32 s42, 9
  s_cselect_b32 s43, 9, 0
  s_sub_u32 s42, s42, s43
  s_lshl_b32 s42, s42, 7
  s_add_u32 s38, s33, s42
  s_add_u32 m0, s48, 18432
  s_add_u32 s42, s38, 0
  buffer_load_dwordx4 v3, s[8:11], s42 offen lds
  s_add_u32 m0, s48, 26624
  s_add_u32 s42, s38, 73728
  buffer_load_dwordx4 v3, s[8:11], s42 offen lds
  s_cmp_lt_u32 s30, 2
  s_cbranch_scc0 Lw3_23
  s_add_u32 m0, s48, 34816
  s_add_u32 s42, s38, 147456
  buffer_load_dwordx4 v3, s[8:11], s42 offen lds
Lw3_23:
  s_add_u32 s42, s49, 2
  s_cmp_ge_u32 s42, 9
  s_cselect_b32 s43, 9, 0
  s_sub_u32 s42, s42, s43
  s_lshl_b32 s42, s42, 7
  s_add_u32 s38, s33, s42
  s_add_u32 m0, s48, 36864
  s_add_u32 s42, s38, 0
  buffer_load_dwordx4 v3, s[8:11], s42 offen lds
  s_add_u32 m0, s48, 45056
  s_add_u32 s42, s38, 73728
  buffer_load_dwordx4 v3, s[8:11], s42 offen lds
  s_cmp_lt_u32 s30, 2
  s_cbranch_scc0 Lw3_24
  s_add_u32 m0, s48, 53248
  s_add_u32 s42, s38, 147456
  buffer_load_dwordx4 v3, s[8:11], s42 offen lds
Lw3_24:
  v_min_f32 v16, 0, v80
  v_min_f32 v17, 0, v81
  v_min_f32 v18, 0, v82
  v_min_f32 v19, 0, v83
  v_mul_f32 v16, s82, v16
  v_mul_f32 v17, s82, v17
  v_mul_f32 v18, s82, v18
  v_mul_f32 v19, s82, v19
  v_max_f32 v20, 0, v80
  v_max_f32 v21, 0, v81
  v_max_f32 v22, 0, v82
  v_max_f32 v23, 0, v83
  v_exp_f32 v16, v16
  v_exp_f32 v17, v17
  v_exp_f32 v18, v18
  v_exp_f32 v19, v19
  v_add_f32 v20, s83, v20
  v_add_f32 v21, s83, v21
  v_add_f32 v22, s83, v22
  v_add_f32 v23, s83, v23
  v_add_f32 v16, v16, v20
  v_add_f32 v17, v17, v21
  v_add_f32 v18, v18, v22
  v_add_f32 v19, v19, v23
  v_cndmask_b32 v16, v80, v16, s[56:57]
  v_cndmask_b32 v17, v81, v17, s[56:57]
  v_cndmask_b32 v18, v82, v18, s[56:57]
  v_cndmask_b32 v19, v83, v19, s[56:57]
  v_cvt_pk_bf16_f32 v24, v16, v17
  v_cvt_pk_bf16_f32 v25, v18, v19
  ds_write_b64 v63, v[24:25] offset:0
  v_min_f32 v16, 0, v84
  v_min_f32 v17, 0, v85
  v_min_f32 v18, 0, v86
  v_min_f32 v19, 0, v87
  v_mul_f32 v16, s82, v16
  v_mul_f32 v17, s82, v17
  v_mul_f32 v18, s82, v18
  v_mul_f32 v19, s82, v19
  v_max_f32 v20, 0, v84
  v_max_f32 v21, 0, v85
  v_max_f32 v22, 0, v86
  v_max_f32 v23, 0, v87
  v_exp_f32 v16, v16
  v_exp_f32 v17, v17
  v_exp_f32 v18, v18
  v_exp_f32 v19, v19
  v_add_f32 v20, s83, v20
  v_add_f32 v21, s83, v21
  v_add_f32 v22, s83, v22
  v_add_f32 v23, s83, v23
  v_add_f32 v16, v16, v20
  v_add_f32 v17, v17, v21
  v_add_f32 v18, v18, v22
  v_add_f32 v19, v19, v23
  v_cndmask_b32 v16, v84, v16, s[56:57]
  v_cndmask_b32 v17, v85, v17, s[56:57]
  v_cndmask_b32 v18, v86, v18, s[56:57]
  v_cndmask_b32 v19, v87, v19, s[56:57]
  v_cvt_pk_bf16_f32 v26, v16, v17
  v_cvt_pk_bf16_f32 v27, v18, v19
  ds_write_b64 v63, v[26:27] offset:16
  v_min_f32 v16, 0, v88
  v_min_f32 v17, 0, v89
  v_min_f32 v18, 0, v90
  v_min_f32 v19, 0, v91
  v_mul_f32 v16, s82, v16
  v_mul_f32 v17, s82, v17
  v_mul_f32 v18, s82, v18
  v_mul_f32 v19, s82, v19
  v_max_f32 v20, 0, v88
  v_max_f32 v21, 0, v89
  v_max_f32 v22, 0, v90
  v_max_f32 v23, 0, v91
  v_exp_f32 v16, v16
  v_exp_f32 v17, v17
  v_exp_f32 v18, v18
  v_exp_f32 v19, v19
  v_add_f32 v20, s83, v20
  v_add_f32 v21, s83, v21
  v_add_f32 v22, s83, v22
  v_add_f32 v23, s83, v23
  v_add_f32 v16, v16, v20
  v_add_f32 v17, v17, v21
  v_add_f32 v18, v18, v22
  v_add_f32 v19, v19, v23
  v_cndmask_b32 v16, v88, v16, s[56:57]
  v_cndmask_b32 v17, v89, v17, s[56:57]
  v_cndmask_b32 v18, v90, v18, s[56:57]
  v_cndmask_b32 v19, v91, v19, s[56:57]
  v_cvt_pk_bf16_f32 v28, v16, v17
  v_cvt_pk_bf16_f32 v29, v18, v19
  ds_write_b64 v63, v[28:29] offset:32
  v_min_f32 v16, 0, v92
  v_min_f32 v17, 0, v93
  v_min_f32 v18, 0, v94
  v_min_f32 v19, 0, v95
  v_mul_f32 v16, s82, v16
  v_mul_f32 v17, s82, v17
  v_mul_f32 v18, s82, v18
  v_mul_f32 v19, s82, v19
  v_max_f32 v20, 0, v92
  v_max_f32 v21, 0, v93
  v_max_f32 v22, 0, v94
  v_max_f32 v23, 0, v95
  v_exp_f32 v16, v16
  v_exp_f32 v17, v17
  v_exp_f32 v18, v18
  v_exp_f32 v19, v19
  v_add_f32 v20, s83, v20
  v_add_f32 v21, s83, v21
  v_add_f32 v22, s83, v22
  v_add_f32 v23, s83, v23
  v_add_f32 v16, v16, v20
  v_add_f32 v17, v17, v21
  v_add_f32 v18, v18, v22
  v_add_f32 v19, v19, v23
  v_cndmask_b32 v16, v92, v16, s[56:57]
  v_cndmask_b32 v17, v93, v17, s[56:57]
  v_cndmask_b32 v18, v94, v18, s[56:57]
  v_cndmask_b32 v19, v95, v19, s[56:57]
  v_cvt_pk_bf16_f32 v30, v16, v17
  v_cvt_pk_bf16_f32 v31, v18, v19
  ds_write_b64 v63, v[30:31] offset:48
  s_cmp_eq_u32 s31, s29
  s_cbranch_scc0 L_nogate
  v_lshrrev_b32 v61, 5, v1
  v_lshlrev_b32 v61, 4, v61
  v_add_u32 v61, 152576, v61
  v_mov_b32 v13, 0
  s_cmp_eq_u32 s32, 1
  s_cbranch_scc1 L_gate1
  ds_read_b128 v[32:35], v61 offset:0
  ds_read_b128 v[36:39], v61 offset:32
  ds_read_b128 v[40:43], v61 offset:64
  ds_read_b128 v[44:47], v61 offset:96
  s_waitcnt lgkmcnt(3)
  v_dot2c_f32_bf16 v13, v32, v112
  v_dot2c_f32_bf16 v13, v33, v113
  v_dot2c_f32_bf16 v13, v34, v114
  v_dot2c_f32_bf16 v13, v35, v115
  ds_read_b128 v[32:35], v61 offset:128
  s_waitcnt lgkmcnt(3)
  v_dot2c_f32_bf16 v13, v36, v116
  v_dot2c_f32_bf16 v13, v37, v117
  v_dot2c_f32_bf16 v13, v38, v118
  v_dot2c_f32_bf16 v13, v39, v119
  ds_read_b128 v[36:39], v61 offset:160
  s_waitcnt lgkmcnt(3)
  v_dot2c_f32_bf16 v13, v40, v120
  v_dot2c_f32_bf16 v13, v41, v121
  v_dot2c_f32_bf16 v13, v42, v122
  v_dot2c_f32_bf16 v13, v43, v123
  ds_read_b128 v[40:43], v61 offset:192
  s_waitcnt lgkmcnt(3)
  v_dot2c_f32_bf16 v13, v44, v124
  v_dot2c_f32_bf16 v13, v45, v125
  v_dot2c_f32_bf16 v13, v46, v126
  v_dot2c_f32_bf16 v13, v47, v127
  ds_read_b128 v[44:47], v61 offset:224
  s_waitcnt lgkmcnt(3)
  v_dot2c_f32_bf16 v13, v32, v128
  v_dot2c_f32_bf16 v13, v33, v129
  v_dot2c_f32_bf16 v13, v34, v130
  v_dot2c_f32_bf16 v13, v35, v131
  ds_read_b128 v[32:35], v61 offset:256
  s_waitcnt lgkmcnt(3)
  v_dot2c_f32_bf16 v13, v36, v132
  v_dot2c_f32_bf16 v13, v37, v133
  v_dot2c_f32_bf16 v13, v38, v134
  v_dot2c_f32_bf16 v13, v39, v135
  ds_read_b128 v[36:39], v61 offset:288
  s_waitcnt lgkmcnt(3)
  v_dot2c_f32_bf16 v13, v40, v136
  v_dot2c_f32_bf16 v13, v41, v137
  v_dot2c_f32_bf16 v13, v42, v138
  v_dot2c_f32_bf16 v13, v43, v139
  ds_read_b128 v[40:43], v61 offset:320
  s_waitcnt lgkmcnt(3)
  v_dot2c_f32_bf16 v13, v44, v140
  v_dot2c_f32_bf16 v13, v45, v141
  v_dot2c_f32_bf16 v13, v46, v142
  v_dot2c_f32_bf16 v13, v47, v143
  ds_read_b128 v[44:47], v61 offset:352
  s_waitcnt lgkmcnt(3)
  v_dot2c_f32_bf16 v13, v32, v144
  v_dot2c_f32_bf16 v13, v33, v145
  v_dot2c_f32_bf16 v13, v34, v146
  v_dot2c_f32_bf16 v13, v35, v147
  ds_read_b128 v[32:35], v61 offset:384
  s_waitcnt lgkmcnt(3)
  v_dot2c_f32_bf16 v13, v36, v148
  v_dot2c_f32_bf16 v13, v37, v149
  v_dot2c_f32_bf16 v13, v38, v150
  v_dot2c_f32_bf16 v13, v39, v151
  ds_read_b128 v[36:39], v61 offset:416
  s_waitcnt lgkmcnt(3)
  v_dot2c_f32_bf16 v13, v40, v152
  v_dot2c_f32_bf16 v13, v41, v153
  v_dot2c_f32_bf16 v13, v42, v154
  v_dot2c_f32_bf16 v13, v43, v155
  ds_read_b128 v[40:43], v61 offset:448
  s_waitcnt lgkmcnt(3)
  v_dot2c_f32_bf16 v13, v44, v156
  v_dot2c_f32_bf16 v13, v45, v157
  v_dot2c_f32_bf16 v13, v46, v158
  v_dot2c_f32_bf16 v13, v47, v159
  ds_read_b128 v[44:47], v61 offset:480
  s_waitcnt lgkmcnt(3)
  v_dot2c_f32_bf16 v13, v32, v160
  v_dot2c_f32_bf16 v13, v33, v161
  v_dot2c_f32_bf16 v13, v34, v162
  v_dot2c_f32_bf16 v13, v35, v163
  ds_read_b128 v[32:35], v61 offset:512
  s_waitcnt lgkmcnt(3)
  v_dot2c_f32_bf16 v13, v36, v164
  v_dot2c_f32_bf16 v13, v37, v165
  v_dot2c_f32_bf16 v13, v38, v166
  v_dot2c_f32_bf16 v13, v39, v167
  ds_read_b128 v[36:39], v61 offset:544
  s_waitcnt lgkmcnt(3)
  v_dot2c_f32_bf16 v13, v40, v168
  v_dot2c_f32_bf16 v13, v41, v169
  v_dot2c_f32_bf16 v13, v42, v170
  v_dot2c_f32_bf16 v13, v43, v171
  s_waitcnt lgkmcnt(2)
  v_dot2c_f32_bf16 v13, v44, v172
  v_dot2c_f32_bf16 v13, v45, v173
  v_dot2c_f32_bf16 v13, v46, v174
  v_dot2c_f32_bf16 v13, v47, v175
  s_waitcnt lgkmcnt(1)
  v_dot2c_f32_bf16 v13, v32, v176
  v_dot2c_f32_bf16 v13, v33, v177
  v_dot2c_f32_bf16 v13, v34, v178
  v_dot2c_f32_bf16 v13, v35, v179
  s_waitcnt lgkmcnt(0)
  v_dot2c_f32_bf16 v13, v36, v180
  v_dot2c_f32_bf16 v13, v37, v181
  v_dot2c_f32_bf16 v13, v38, v182
  v_dot2c_f32_bf16 v13, v39, v183
  s_branch L_gate2
L_gate1:
  ds_read_b128 v[32:35], v61 offset:576
  ds_read_b128 v[36:39], v61 offset:608
  ds_read_b128 v[40:43], v61 offset:640
  ds_read_b128 v[44:47], v61 offset:672
  s_waitcnt lgkmcnt(3)
  v_dot2c_f32_bf16 v13, v32, v184
  v_dot2c_f32_bf16 v13, v33, v185
  v_dot2c_f32_bf16 v13, v34, v186
  v_dot2c_f32_bf16 v13, v35, v187
  ds_read_b128 v[32:35], v61 offset:704
  s_waitcnt lgkmcnt(3)
  v_dot2c_f32_bf16 v13, v36, v188
  v_dot2c_f32_bf16 v13, v37, v189
  v_dot2c_f32_bf16 v13, v38, v190
  v_dot2c_f32_bf16 v13, v39, v191
  ds_read_b128 v[36:39], v61 offset:736
  s_waitcnt lgkmcnt(3)
  v_dot2c_f32_bf16 v13, v40, v192
  v_dot2c_f32_bf16 v13, v41, v193
  v_dot2c_f32_bf16 v13, v42, v194
  v_dot2c_f32_bf16 v13, v43, v195
  ds_read_b128 v[40:43], v61 offset:768
  s_waitcnt lgkmcnt(3)
  v_dot2c_f32_bf16 v13, v44, v196
  v_dot2c_f32_bf16 v13, v45, v197
  v_dot2c_f32_bf16 v13, v46, v198
  v_dot2c_f32_bf16 v13, v47, v199
  ds_read_b128 v[44:47], v61 offset:800
  s_waitcnt lgkmcnt(3)
  v_dot2c_f32_bf16 v13, v32, v200
  v_dot2c_f32_bf16 v13, v33, v201
  v_dot2c_f32_bf16 v13, v34, v202
  v_dot2c_f32_bf16 v13, v35, v203
  ds_read_b128 v[32:35], v61 offset:832
  s_waitcnt lgkmcnt(3)
  v_dot2c_f32_bf16 v13, v36, v204
  v_dot2c_f32_bf16 v13, v37, v205
  v_dot2c_f32_bf16 v13, v38, v206
  v_dot2c_f32_bf16 v13, v39, v207
  ds_read_b128 v[36:39], v61 offset:864
  s_waitcnt lgkmcnt(3)
  v_dot2c_f32_bf16 v13, v40, v208
  v_dot2c_f32_bf16 v13, v41, v209
  v_dot2c_f32_bf16 v13, v42, v210
  v_dot2c_f32_bf16 v13, v43, v211
  ds_read_b128 v[40:43], v61 offset:896
  s_waitcnt lgkmcnt(3)
  v_dot2c_f32_bf16 v13, v44, v212
  v_dot2c_f32_bf16 v13, v45, v213
  v_dot2c_f32_bf16 v13, v46, v214
  v_dot2c_f32_bf16 v13, v47, v215
  ds_read_b128 v[44:47], v61 offset:928
  s_waitcnt lgkmcnt(3)
  v_dot2c_f32_bf16 v13, v32, v216
  v_dot2c_f32_bf16 v13, v33, v217
  v_dot2c_f32_bf16 v13, v34, v218
  v_dot2c_f32_bf16 v13, v35, v219
  ds_read_b128 v[32:35], v61 offset:960
  s_waitcnt lgkmcnt(3)
  v_dot2c_f32_bf16 v13, v36, v220
  v_dot2c_f32_bf16 v13, v37, v221
  v_dot2c_f32_bf16 v13, v38, v222
  v_dot2c_f32_bf16 v13, v39, v223
  ds_read_b128 v[36:39], v61 offset:992
  s_waitcnt lgkmcnt(3)
  v_dot2c_f32_bf16 v13, v40, v224
  v_dot2c_f32_bf16 v13, v41, v225
  v_dot2c_f32_bf16 v13, v42, v226
  v_dot2c_f32_bf16 v13, v43, v227
  ds_read_b128 v[40:43], v61 offset:1024
  s_waitcnt lgkmcnt(3)
  v_dot2c_f32_bf16 v13, v44, v228
  v_dot2c_f32_bf16 v13, v45, v229
  v_dot2c_f32_bf16 v13, v46, v230
  v_dot2c_f32_bf16 v13, v47, v231
  ds_read_b128 v[44:47], v61 offset:1056
  s_waitcnt lgkmcnt(3)
  v_dot2c_f32_bf16 v13, v32, v232
  v_dot2c_f32_bf16 v13, v33, v233
  v_dot2c_f32_bf16 v13, v34, v234
  v_dot2c_f32_bf16 v13, v35, v235
  ds_read_b128 v[32:35], v61 offset:1088
  s_waitcnt lgkmcnt(3)
  v_dot2c_f32_bf16 v13, v36, v236
  v_dot2c_f32_bf16 v13, v37, v237
  v_dot2c_f32_bf16 v13, v38, v238
  v_dot2c_f32_bf16 v13, v39, v239
  ds_read_b128 v[36:39], v61 offset:1120
  s_waitcnt lgkmcnt(3)
  v_dot2c_f32_bf16 v13, v40, v240
  v_dot2c_f32_bf16 v13, v41, v241
  v_dot2c_f32_bf16 v13, v42, v242
  v_dot2c_f32_bf16 v13, v43, v243
  s_waitcnt lgkmcnt(2)
  v_dot2c_f32_bf16 v13, v44, v244
  v_dot2c_f32_bf16 v13, v45, v245
  v_dot2c_f32_bf16 v13, v46, v246
  v_dot2c_f32_bf16 v13, v47, v247
  s_waitcnt lgkmcnt(1)
  v_dot2c_f32_bf16 v13, v32, v248
  v_dot2c_f32_bf16 v13, v33, v249
  v_dot2c_f32_bf16 v13, v34, v250
  v_dot2c_f32_bf16 v13, v35, v251
  s_waitcnt lgkmcnt(0)
  v_dot2c_f32_bf16 v13, v36, v252
  v_dot2c_f32_bf16 v13, v37, v253
  v_dot2c_f32_bf16 v13, v38, v254
  v_dot2c_f32_bf16 v13, v39, v255
L_gate2:
  s_nop 4
  v_mov_b32 v62, v13
  s_nop 1
  v_permlane32_swap_b32 v13, v62
  s_nop 1
  v_add_f32 v13, v13, v62
  s_lshl_b32 s43, s32, 7
  s_add_u32 s43, s43, 153728
  v_lshrrev_b32 v62, 2, v9
  v_add_u32 v62, s43, v62
  ds_write_b32 v62, v13
L_nogate:
  v_and_b32 v102, 15, v1
  v_lshrrev_b32 v102, 2, v102
  v_lshrrev_b32 v106, 5, v1
  v_lshlrev_b32 v107, 3, v106
  v_add_u32 v102, v102, v107
  v_mul_u32_u24 v102, 272, v102
  v_lshrrev_b32 v107, 4, v1
  v_and_b32 v107, 1, v107
  v_lshlrev_b32 v107, 5, v107
  v_add_u32 v102, v102, v107
  v_and_b32 v107, 3, v1
  v_lshlrev_b32 v107, 3, v107
  v_add_u32 v102, v102, v107
  s_lshl_b32 s42, s31, 6
  s_mul_i32 s43, s32, 19584
  s_add_u32 s42, s42, s43
  s_add_u32 s42, s42, 65536
  v_add_u32 v102, s42, v102
  v_lshlrev_b32 v103, 2, v9
  v_lshlrev_b32 v107, 4, v106
  v_add_u32 v103, v103, v107
  s_lshl_b32 s42, s32, 13
  s_add_u32 s42, s42, 108512
  v_add_u32 v103, s42, v103
  v_lshrrev_b32 v104, 4, v9
  v_mul_u32_u24 v104, 304, v104
  v_add_u32 v105, v104, v107
  v_lshlrev_b32 v107, 3, v106
  v_add_u32 v104, v104, v107
  s_mul_i32 s42, s31, 9728
  s_add_u32 s42, s42, 124896
  v_add_u32 v105, s42, v105
  s_mul_i32 s43, s32, 144
  s_add_u32 s42, s42, s43
  v_add_u32 v104, s42, v104
  s_waitcnt vmcnt(6)
  v_lshlrev_b32 v56, 4, v0
  v_add_u32 v56, 124896, v56
  ds_write_b128 v56, v[64:67]
  ds_write_b128 v56, v[68:71] offset:8192
  s_waitcnt lgkmcnt(0)
  s_barrier
  ds_read_b64_tr_b16 v[120:121], v102 offset:0
  ds_read_b64_tr_b16 v[122:123], v102 offset:1088
  ds_read_b64_tr_b16 v[124:125], v102 offset:4352
  ds_read_b64_tr_b16 v[126:127], v102 offset:5440
  ds_read_b64_tr_b16 v[136:137], v102 offset:4896
  ds_read_b64_tr_b16 v[138:139], v102 offset:5984
  ds_read_b64_tr_b16 v[140:141], v102 offset:9248
  ds_read_b64_tr_b16 v[142:143], v102 offset:10336
  ds_read_b64_tr_b16 v[152:153], v102 offset:9792
  ds_read_b64_tr_b16 v[154:155], v102 offset:10880
  ds_read_b64_tr_b16 v[156:157], v102 offset:14144
  ds_read_b64_tr_b16 v[158:159], v102 offset:15232
  ds_read_b64_tr_b16 v[168:169], v102 offset:14688
  ds_read_b64_tr_b16 v[170:171], v102 offset:15776
  ds_read_b64_tr_b16 v[172:173], v102 offset:19040
  ds_read_b64_tr_b16 v[174:175], v102 offset:20128
  v_lshrrev_b32 v56, 4, v9
  v_lshrrev_b32 v57, 5, v1
  v_mul_u32_u24 v58, 1280, v57
  v_min_u32 v59, 19, v56
  v_lshlrev_b32 v59, 2, v59
  v_add_u32 v58, v58, v59
  s_mul_i32 s42, s30, 1440
  s_add_u32 s42, s42, 124896
  v_add_u32 v58, s42, v58
  ds_read_b32 v80, v58 offset:0
  ds_read_b32 v81, v58 offset:80
  ds_read_b32 v82, v58 offset:160
  ds_read_b32 v83, v58 offset:240
  ds_read_b32 v84, v58 offset:320
  ds_read_b32 v85, v58 offset:400
  ds_read_b32 v86, v58 offset:480
  ds_read_b32 v87, v58 offset:560
  ds_read_b32 v88, v58 offset:640
  ds_read_b32 v89, v58 offset:720
  ds_read_b32 v90, v58 offset:800
  ds_read_b32 v91, v58 offset:880
  ds_read_b32 v92, v58 offset:960
  ds_read_b32 v93, v58 offset:1040
  ds_read_b32 v94, v58 offset:1120
  ds_read_b32 v95, v58 offset:1200
  v_cmp_gt_u32 vcc, 19, v56
  v_mov_b32 v59, 32
  v_cmp_lt_u32 s[56:57], v1, v59
  s_nop 3
  s_and_b64 s[56:57], s[56:57], vcc
  s_waitcnt lgkmcnt(0)
  v_cndmask_b32 v80, 0, v80, vcc
  v_cndmask_b32 v81, 0, v81, vcc
  v_cndmask_b32 v82, 0, v82, s[56:57]
  v_cndmask_b32 v83, 0, v83, s[56:57]
  v_cndmask_b32 v84, 0, v84, s[56:57]
  v_cndmask_b32 v85, 0, v85, s[56:57]
  v_cndmask_b32 v86, 0, v86, s[56:57]
  v_cndmask_b32 v87, 0, v87, s[56:57]
  v_cndmask_b32 v88, 0, v88, s[56:57]
  v_cndmask_b32 v89, 0, v89, s[56:57]
  v_cndmask_b32 v90, 0, v90, s[56:57]
  v_cndmask_b32 v91, 0, v91, s[56:57]
  v_cndmask_b32 v92, 0, v92, s[56:57]
  v_cndmask_b32 v93, 0, v93, s[56:57]
  v_cndmask_b32 v94, 0, v94, s[56:57]
  v_cndmask_b32 v95, 0, v95, s[56:57]
  v_cvt_pk_bf16_f32 v24, v80, v81
  v_cvt_pk_bf16_f32 v25, v82, v83
  v_cvt_pk_bf16_f32 v26, v84, v85
  v_cvt_pk_bf16_f32 v27, v86, v87
  v_cvt_pk_bf16_f32 v28, v88, v89
  v_cvt_pk_bf16_f32 v29, v90, v91
  v_cvt_pk_bf16_f32 v30, v92, v93
  v_cvt_pk_bf16_f32 v31, v94, v95
  s_lshl_b32 s42, s30, 11
  s_add_u32 s42, s42, 108512
  v_lshlrev_b32 v56, 2, v9
  v_lshrrev_b32 v57, 5, v1
  v_lshlrev_b32 v57, 5, v57
  v_add_u32 v56, v56, v57
  v_add_u32 v56, s42, v56
  ds_write_b128 v56, v[24:27]
  ds_write_b128 v56, v[28:31] offset:16
  s_waitcnt lgkmcnt(0)
  s_barrier
  s_cmp_eq_u32 s30, s29
  s_cbranch_scc0 L_nogate2
  v_lshrrev_b32 v62, 2, v9
  v_add_u32 v61, 153728, v62
  ds_read_b32 v13, v61
  ds_read_b32 v60, v61 offset:128
  s_waitcnt lgkmcnt(0)
  v_add_f32 v13, v13, v60
  v_mul_f32 v13, 0xbfb8aa3b, v13
  v_exp_f32 v13, v13
  s_nop 0
  v_add_f32 v13, 1.0, v13
  v_rcp_f32 v13, v13
  s_lshl_b32 s42, s28, 7
  s_lshl_b32 s43, s29, 5
  s_add_u32 s42, s42, s43
  s_lshl_b32 s42, s42, 2
  s_add_u32 s42, s42, 38043648
  s_mov_b32 exec_hi, 0
  buffer_store_dword v13, v62, s[12:15], s42 offen sc0 sc1
  s_mov_b32 exec_hi, -1
L_nogate2:
  ds_read_b128 v[112:115], v103 offset:0
  ds_read_b128 v[116:119], v103 offset:32
  ds_read_b128 v[128:131], v103 offset:2048
  ds_read_b128 v[132:135], v103 offset:2080
  ds_read_b128 v[144:147], v103 offset:4096
  ds_read_b128 v[148:151], v103 offset:4128
  ds_read_b128 v[160:163], v103 offset:6144
  ds_read_b128 v[164:167], v103 offset:6176
  s_waitcnt lgkmcnt(0)
  v_mfma_f32_32x32x16_bf16 v[176:191], v[112:115], v[120:123], 0
  v_mfma_f32_32x32x16_bf16 v[176:191], v[116:119], v[124:127], v[176:191]
  v_mfma_f32_32x32x16_bf16 v[192:207], v[128:131], v[136:139], 0
  v_mfma_f32_32x32x16_bf16 v[192:207], v[132:135], v[140:143], v[192:207]
  v_mfma_f32_32x32x16_bf16 v[208:223], v[144:147], v[152:155], 0
  v_mfma_f32_32x32x16_bf16 v[208:223], v[148:151], v[156:159], v[208:223]
  v_mfma_f32_32x32x16_bf16 v[224:239], v[160:163], v[168:171], 0
  v_mfma_f32_32x32x16_bf16 v[224:239], v[164:167], v[172:175], v[224:239]
  s_nop 15
  s_nop 3
  v_mov_b32 v16, v186
  v_mov_b32 v17, v186
  v_mov_b32 v18, v202
  v_mov_b32 v19, v202
  v_mov_b32 v20, v218
  v_mov_b32 v21, v218
  v_mov_b32 v22, v234
  v_mov_b32 v23, v234
  s_nop 1
  v_permlane32_swap_b32 v17, v16
  v_permlane32_swap_b32 v19, v18
  v_permlane32_swap_b32 v21, v20
  v_permlane32_swap_b32 v23, v22
  s_nop 1
  v_add_f32 v17, s83, v17
  v_add_f32 v19, s83, v19
  v_add_f32 v21, s83, v21
  v_add_f32 v23, s83, v23
  v_rcp_f32 v17, v17
  v_rcp_f32 v19, v19
  v_rcp_f32 v21, v21
  v_rcp_f32 v23, v23
  s_nop 0
  v_mul_f32 v176, v176, v17
  v_mul_f32 v177, v177, v17
  v_mul_f32 v178, v178, v17
  v_mul_f32 v179, v179, v17
  v_mul_f32 v180, v180, v17
  v_mul_f32 v181, v181, v17
  v_mul_f32 v182, v182, v17
  v_mul_f32 v183, v183, v17
  v_mul_f32 v184, v184, v17
  v_mul_f32 v185, v185, v17
  v_cvt_pk_bf16_f32 v32, v176, v177
  v_cvt_pk_bf16_f32 v33, v178, v179
  v_cvt_pk_bf16_f32 v34, v180, v181
  v_cvt_pk_bf16_f32 v35, v182, v183
  v_cvt_pk_bf16_f32 v36, v184, v185
  ds_write_b64 v104, v[32:33] offset:0
  ds_write_b64 v104, v[34:35] offset:16
  v_mul_f32 v192, v192, v19
  v_mul_f32 v193, v193, v19
  v_mul_f32 v194, v194, v19
  v_mul_f32 v195, v195, v19
  v_mul_f32 v196, v196, v19
  v_mul_f32 v197, v197, v19
  v_mul_f32 v198, v198, v19
  v_mul_f32 v199, v199, v19
  v_mul_f32 v200, v200, v19
  v_mul_f32 v201, v201, v19
  v_cvt_pk_bf16_f32 v38, v192, v193
  v_cvt_pk_bf16_f32 v39, v194, v195
  v_cvt_pk_bf16_f32 v40, v196, v197
  v_cvt_pk_bf16_f32 v41, v198, v199
  v_cvt_pk_bf16_f32 v42, v200, v201
  ds_write_b32 v104, v38 offset:36
  ds_write_b32 v104, v39 offset:40
  ds_write_b32 v104, v40 offset:52
  ds_write_b32 v104, v41 offset:56
  v_mul_f32 v208, v208, v21
  v_mul_f32 v209, v209, v21
  v_mul_f32 v210, v210, v21
  v_mul_f32 v211, v211, v21
  v_mul_f32 v212, v212, v21
  v_mul_f32 v213, v213, v21
  v_mul_f32 v214, v214, v21
  v_mul_f32 v215, v215, v21
  v_mul_f32 v216, v216, v21
  v_mul_f32 v217, v217, v21
  v_cvt_pk_bf16_f32 v44, v208, v209
  v_cvt_pk_bf16_f32 v45, v210, v211
  v_cvt_pk_bf16_f32 v46, v212, v213
  v_cvt_pk_bf16_f32 v47, v214, v215
  v_cvt_pk_bf16_f32 v48, v216, v217
  ds_write_b64 v104, v[44:45] offset:72
  ds_write_b64 v104, v[46:47] offset:88
  v_mul_f32 v224, v224, v23
  v_mul_f32 v225, v225, v23
  v_mul_f32 v226, v226, v23
  v_mul_f32 v227, v227, v23
  v_mul_f32 v228, v228, v23
  v_mul_f32 v229, v229, v23
  v_mul_f32 v230, v230, v23
  v_mul_f32 v231, v231, v23
  v_mul_f32 v232, v232, v23
  v_mul_f32 v233, v233, v23
  v_cvt_pk_bf16_f32 v50, v224, v225
  v_cvt_pk_bf16_f32 v51, v226, v227
  v_cvt_pk_bf16_f32 v52, v228, v229
  v_cvt_pk_bf16_f32 v53, v230, v231
  v_cvt_pk_bf16_f32 v54, v232, v233
  ds_write_b32 v104, v50 offset:108
  ds_write_b32 v104, v51 offset:112
  ds_write_b32 v104, v52 offset:124
  ds_write_b32 v104, v53 offset:128
  s_mov_b32 exec_hi, 0
  ds_write_b32 v104, v36 offset:32
  ds_write_b32 v104, v42 offset:68
  ds_write_b32 v104, v48 offset:104
  ds_write_b32 v104, v54 offset:140
  s_mov_b32 exec_hi, -1
  s_waitcnt vmcnt(0) lgkmcnt(0)
  s_barrier
  ds_read_b128 v[112:115], v105 offset:0
  ds_read_b128 v[116:119], v105 offset:32
  ds_read_b128 v[120:123], v105 offset:64
  ds_read_b128 v[124:127], v105 offset:96
  ds_read_b128 v[128:131], v105 offset:128
  ds_read_b128 v[132:135], v105 offset:160
  ds_read_b128 v[136:139], v105 offset:192
  ds_read_b128 v[140:143], v105 offset:224
  ds_read_b128 v[144:147], v105 offset:256
  s_waitcnt lgkmcnt(0)
  s_barrier
  s_lshl_b32 s42, s28, 2
  s_add_u32 s42, s42, s31
  s_mul_i32 s42, s42, 288
  s_add_u32 s42, s42, s29
  s_add_u32 s42, s42, 12
  s_lshl_b32 s46, s42, 11
  s_add_u32 s46, s46, 0
  s_lshl_b32 s42, s32, 15
  s_add_u32 s46, s46, s42
  s_mov_b32 s40, s49
  s_mov_b32 s34, 0
  s_mov_b32 s45, 1073741824
  v_mov_b32 v6, v5
  ds_read_b64_tr_b16 v[152:153], v6 offset:0
  ds_read_b64_tr_b16 v[154:155], v6 offset:512
  ds_read_b64_tr_b16 v[156:157], v6 offset:2048
  ds_read_b64_tr_b16 v[158:159], v6 offset:2560
  ds_read_b64_tr_b16 v[160:161], v6 offset:4096
  ds_read_b64_tr_b16 v[162:163], v6 offset:4608
  ds_read_b64_tr_b16 v[164:165], v6 offset:6144
  ds_read_b64_tr_b16 v[166:167], v6 offset:6656
  ds_read_b64_tr_b16 v[168:169], v6 offset:8192
  ds_read_b64_tr_b16 v[170:171], v6 offset:8704
  ds_read_b64_tr_b16 v[172:173], v6 offset:10240
  ds_read_b64_tr_b16 v[174:175], v6 offset:10752
  ds_read_b64_tr_b16 v[176:177], v6 offset:12288
  ds_read_b64_tr_b16 v[178:179], v6 offset:12800
  ds_read_b64_tr_b16 v[180:181], v6 offset:14336
  ds_read_b64_tr_b16 v[182:183], v6 offset:14848
  ds_read_b64_tr_b16 v[184:185], v6 offset:16384
  ds_read_b64_tr_b16 v[186:187], v6 offset:16896
  s_mov_b32 s35, 18432
  .p2align 3
L_W:
  s_cmp_le_u32 s34, 6
  s_cbranch_scc1 L_W_act
L_W_go:
  v_add_u32 v6, s35, v5
  s_waitcnt lgkmcnt(12)
  v_mfma_f32_32x32x16_bf16 v[64:79], v[152:155], v[112:115], 0
  ds_read_b64_tr_b16 v[152:153], v6 offset:0
  ds_read_b64_tr_b16 v[154:155], v6 offset:512
  v_mfma_f32_32x32x16_bf16 v[64:79], v[156:159], v[116:119], v[64:79]
  v_cvt_pk_bf16_f32 v24, v80, v81
  v_cvt_pk_bf16_f32 v25, v82, v83
  v_cvt_pk_bf16_f32 v26, v84, v85
  v_cvt_pk_bf16_f32 v27, v86, v87
  ds_read_b64_tr_b16 v[156:157], v6 offset:2048
  ds_read_b64_tr_b16 v[158:159], v6 offset:2560
  v_mfma_f32_32x32x16_bf16 v[64:79], v[160:163], v[120:123], v[64:79]
  v_cvt_pk_bf16_f32 v28, v88, v89
  v_cvt_pk_bf16_f32 v29, v90, v91
  v_cvt_pk_bf16_f32 v30, v92, v93
  v_cvt_pk_bf16_f32 v31, v94, v95
  ds_read_b64_tr_b16 v[160:161], v6 offset:4096
  ds_read_b64_tr_b16 v[162:163], v6 offset:4608
  s_waitcnt lgkmcnt(12)
  v_mfma_f32_32x32x16_bf16 v[64:79], v[164:167], v[124:127], v[64:79]
  ds_read_b64_tr_b16 v[164:165], v6 offset:6144
  ds_read_b64_tr_b16 v[166:167], v6 offset:6656
  buffer_store_dwordx4 v[24:27], v15, s[12:15], s45 offen sc1
  v_mfma_f32_32x32x16_bf16 v[64:79], v[168:171], v[128:131], v[64:79]
  ds_read_b64_tr_b16 v[168:169], v6 offset:8192
  ds_read_b64_tr_b16 v[170:171], v6 offset:8704
  v_mfma_f32_32x32x16_bf16 v[64:79], v[172:175], v[132:135], v[64:79]
  ds_read_b64_tr_b16 v[172:173], v6 offset:10240
  ds_read_b64_tr_b16 v[174:175], v6 offset:10752
  buffer_store_dwordx4 v[28:31], v15, s[12:15], s45 offen offset:1024 sc1
  s_waitcnt lgkmcnt(12)
  v_mfma_f32_32x32x16_bf16 v[64:79], v[176:179], v[136:139], v[64:79]
  ds_read_b64_tr_b16 v[176:177], v6 offset:12288
  ds_read_b64_tr_b16 v[178:179], v6 offset:12800
  s_lshl_b32 s42, s40, 16
  s_add_u32 s45, s46, s42
  s_add_u32 s40, s40, 1
  s_cmp_eq_u32 s40, 9
  s_cselect_b32 s40, 0, s40
  v_mfma_f32_32x32x16_bf16 v[64:79], v[180:183], v[140:143], v[64:79]
  ds_read_b64_tr_b16 v[180:181], v6 offset:14336
  ds_read_b64_tr_b16 v[182:183], v6 offset:14848
  s_add_u32 s34, s34, 1
  s_add_u32 s42, s34, 1
  s_mul_i32 s35, s42, 18432
  s_cmp_ge_u32 s42, 3
  s_cselect_b32 s43, 10240, 0
  s_add_u32 s35, s35, s43
  s_cmp_ge_u32 s42, 8
  s_cselect_b32 s35, 0, s35
  v_mfma_f32_32x32x16_bf16 v[80:95], v[184:187], v[144:147], v[64:79]
  ds_read_b64_tr_b16 v[184:185], v6 offset:16384
  ds_read_b64_tr_b16 v[186:187], v6 offset:16896
  s_cmp_lt_u32 s34, 9
  s_cbranch_scc1 L_W
  s_branch L_W_done
L_W_act:
  s_cmp_eq_u32 s34, 0
  s_cbranch_scc1 L_W_a0
  s_cmp_eq_u32 s34, 1
  s_cbranch_scc1 L_W_a1
  s_cmp_eq_u32 s34, 2
  s_cbranch_scc1 L_W_a2
  s_cmp_eq_u32 s34, 3
  s_cbranch_scc1 L_W_a3
  s_cmp_eq_u32 s34, 4
  s_cbranch_scc1 L_W_a4
  s_cmp_eq_u32 s34, 5
  s_cbranch_scc1 L_W_a5
  s_cmp_eq_u32 s34, 6
  s_cbranch_scc1 L_W_a6
  s_branch L_W_go
L_W_a0:
  s_add_u32 s42, s49, 3
  s_cmp_ge_u32 s42, 9
  s_cselect_b32 s43, 9, 0
  s_sub_u32 s42, s42, s43
  s_lshl_b32 s42, s42, 7
  s_add_u32 s38, s33, s42
  s_add_u32 m0, s48, 65536
  s_add_u32 s42, s38, 0
  buffer_load_dwordx4 v3, s[8:11], s42 offen lds
  s_add_u32 m0, s48, 73728
  s_add_u32 s42, s38, 73728
  buffer_load_dwordx4 v3, s[8:11], s42 offen lds
  s_cmp_lt_u32 s30, 2
  s_cbranch_scc0 Lw3_25
  s_add_u32 m0, s48, 81920
  s_add_u32 s42, s38, 147456
  buffer_load_dwordx4 v3, s[8:11], s42 offen lds
Lw3_25:
  s_add_u32 s42, s49, 4
  s_cmp_ge_u32 s42, 9
  s_cselect_b32 s43, 9, 0
  s_sub_u32 s42, s42, s43
  s_lshl_b32 s42, s42, 7
  s_add_u32 s38, s33, s42
  s_add_u32 m0, s48, 83968
  s_add_u32 s42, s38, 0
  buffer_load_dwordx4 v3, s[8:11], s42 offen lds
  s_add_u32 m0, s48, 92160
  s_add_u32 s42, s38, 73728
  buffer_load_dwordx4 v3, s[8:11], s42 offen lds
  s_cmp_lt_u32 s30, 2
  s_cbranch_scc0 Lw3_26
  s_add_u32 m0, s48, 100352
  s_add_u32 s42, s38, 147456
  buffer_load_dwordx4 v3, s[8:11], s42 offen lds
Lw3_26:
  s_branch L_W_go
L_W_a1:
  s_add_u32 s42, s49, 5
  s_cmp_ge_u32 s42, 9
  s_cselect_b32 s43, 9, 0
  s_sub_u32 s42, s42, s43
  s_lshl_b32 s42, s42, 7
  s_add_u32 s38, s33, s42
  s_add_u32 m0, s48, 102400
  s_add_u32 s42, s38, 0
  buffer_load_dwordx4 v3, s[8:11], s42 offen lds
  s_add_u32 m0, s48, 110592
  s_add_u32 s42, s38, 73728
  buffer_load_dwordx4 v3, s[8:11], s42 offen lds
  s_cmp_lt_u32 s30, 2
  s_cbranch_scc0 Lw3_27
  s_add_u32 m0, s48, 118784
  s_add_u32 s42, s38, 147456
  buffer_load_dwordx4 v3, s[8:11], s42 offen lds
Lw3_27:
  s_add_u32 s42, s49, 6
  s_cmp_ge_u32 s42, 9
  s_cselect_b32 s43, 9, 0
  s_sub_u32 s42, s42, s43
  s_lshl_b32 s42, s42, 7
  s_add_u32 s38, s33, s42
  s_add_u32 m0, s48, 120832
  s_add_u32 s42, s38, 0
  buffer_load_dwordx4 v3, s[8:11], s42 offen lds
  s_add_u32 m0, s48, 129024
  s_add_u32 s42, s38, 73728
  buffer_load_dwordx4 v3, s[8:11], s42 offen lds
  s_cmp_lt_u32 s30, 2
  s_cbranch_scc0 Lw3_28
  s_add_u32 m0, s48, 137216
  s_add_u32 s42, s38, 147456
  buffer_load_dwordx4 v3, s[8:11], s42 offen lds
Lw3_28:
  s_branch L_W_go
L_W_a2:
  s_waitcnt vmcnt(8)
  s_barrier
  s_add_u32 s42, s49, 7
  s_cmp_ge_u32 s42, 9
  s_cselect_b32 s43, 9, 0
  s_sub_u32 s42, s42, s43
  s_lshl_b32 s42, s42, 7
  s_add_u32 s38, s33, s42
  s_add_u32 m0, s48, 139264
  s_add_u32 s42, s38, 0
  buffer_load_dwordx4 v3, s[8:11], s42 offen lds
  s_add_u32 m0, s48, 147456
  s_add_u32 s42, s38, 73728
  buffer_load_dwordx4 v3, s[8:11], s42 offen lds
  s_cmp_lt_u32 s30, 2
  s_cbranch_scc0 Lw3_29
  s_add_u32 m0, s48, 155648
  s_add_u32 s42, s38, 147456
  buffer_load_dwordx4 v3, s[8:11], s42 offen lds
Lw3_29:
  s_add_u32 s42, s49, 8
  s_cmp_ge_u32 s42, 9
  s_cselect_b32 s43, 9, 0
  s_sub_u32 s42, s42, s43
  s_lshl_b32 s42, s42, 7
  s_add_u32 s38, s33, s42
  s_add_u32 m0, s48, 0
  s_add_u32 s42, s38, 0
  buffer_load_dwordx4 v3, s[8:11], s42 offen lds
  s_add_u32 m0, s48, 8192
  s_add_u32 s42, s38, 73728
  buffer_load_dwordx4 v3, s[8:11], s42 offen lds
  s_cmp_lt_u32 s30, 2
  s_cbranch_scc0 Lw3_30
  s_add_u32 m0, s48, 16384
  s_add_u32 s42, s38, 147456
  buffer_load_dwordx4 v3, s[8:11], s42 offen lds
Lw3_30:
  s_branch L_W_go
L_W_a3:
  s_branch L_W_go
L_W_a4:
  s_waitcnt vmcnt(10)
  s_barrier
  s_branch L_W_go
L_W_a5:
  s_branch L_W_go
L_W_a6:
  s_waitcnt vmcnt(8)
  s_barrier
  s_branch L_W_go
L_W_done:
  s_nop 15
  v_cvt_pk_bf16_f32 v24, v80, v81
  v_cvt_pk_bf16_f32 v25, v82, v83
  v_cvt_pk_bf16_f32 v26, v84, v85
  v_cvt_pk_bf16_f32 v27, v86, v87
  v_cvt_pk_bf16_f32 v28, v88, v89
  v_cvt_pk_bf16_f32 v29, v90, v91
  v_cvt_pk_bf16_f32 v30, v92, v93
  v_cvt_pk_bf16_f32 v31, v94, v95
  buffer_store_dwordx4 v[24:27], v15, s[12:15], s45 offen sc1
  buffer_store_dwordx4 v[28:31], v15, s[12:15], s45 offen offset:1024 sc1
  s_waitcnt vmcnt(0) lgkmcnt(0)
  s_add_u32 s62, s29, 12
  s_mov_b64 exec, -1
  v_mov_b32 v56, 252
L_fa_poll:
  buffer_load_dword v57, v56, s[16:19], 0 offen sc1
  s_waitcnt vmcnt(0)
  v_readfirstlane_b32 s52, v57
  s_nop 3
  s_cmp_eq_u32 s52, 0
  s_cbranch_scc1 L_fa_poll
  s_barrier
  s_lshl_b32 s53, s28, 7
  s_add_u32 s53, s53, 38105088
  s_cmp_eq_u32 s30, 0
  s_cbranch_scc0 L_fa_nosig
  s_lshl_b32 s42, s62, 2
  v_mov_b32 v56, s42
  v_mov_b32 v57, s52
  s_mov_b64 exec, 1
  buffer_store_dword v57, v56, s[12:15], s53 offen sc0 sc1
  s_mov_b64 exec, -1
L_fa_nosig:
  s_waitcnt vmcnt(0)
L_end1:

  s_endpgm
.section .rodata,"a"
.p2align 6
.amdhsa_kernel gated_mix__linear_attn_block__mixer_channel_mlp__prompt_kernel
  .amdhsa_next_free_vgpr 256
  .amdhsa_next_free_sgpr 102
  .amdhsa_accum_offset 256
  .amdhsa_group_segment_fixed_size 0
  .amdhsa_kernarg_size 96
  .amdhsa_user_sgpr_count 2
  .amdhsa_user_sgpr_kernarg_segment_ptr 1
  .amdhsa_system_sgpr_workgroup_id_x 1

.end_amdhsa_kernel
```
